```python
import torch

def _softmax(x, axis=-1):
    return torch.softmax(x, dim=axis)

def _gelu(x):
    return torch.nn.functional.gelu(x, approximate='tanh')

def _silu(x):
    return torch.nn.functional.silu(x)

def _sigmoid(x):
    return torch.sigmoid(x)

def _layernorm(x, axis=-1, eps=1e-05):
    m = x.mean(dim=axis, keepdim=True)
    v = x.var(dim=axis, keepdim=True, unbiased=False)
    return (x - m) / torch.sqrt(v + eps)

def _scatter_add(tgt, idx, src, axis=0):
    return tgt.clone().index_add_(axis, idx, src)

def _segment_sum(src, seg, n):
    out = torch.zeros((n,) + src.shape[1:], dtype=src.dtype)
    return out.index_add_(0, seg, src)

def _pad(x, pw):
    flat = tuple((v for pair in reversed(pw) for v in pair))
    return torch.nn.functional.pad(x, flat)
kernel_name = 'standalone__kv_cache_quant_pre_rope_vs_post_rope__decode'

def setup_inputs():

    _w = lambda a: (lambda t: t.to(torch.bfloat16) if t.is_floating_point() else t)(torch.as_tensor(a))
    B, Sq, Skv = (4, 1, 8192)
    H, Dh0 = (4, 128)
    G = 64 if 64 > 0 else Dh0
    G = max(2, G // 2 * 2)
    Dh = max(G, Dh0 // G * G)
    Skv = max(Skv, Sq)
    ng = Dh // G
    bits = 2 if 2 > 1 else 4
    bits = max(2, min(8, bits))
    qmax = (1 << bits) - 1
    half = Dh // 2
    inv = 1.0 / 10000.0 ** (torch.arange(half) / max(1, half))
    ang_k = torch.arange(Skv)[:, None] * inv[None, :]
    ang_q = torch.arange(Skv - Sq, Skv)[:, None] * inv[None, :]
    kc = torch.cat([torch.cos(ang_k), torch.cos(ang_k)], dim=-1)
    ks = torch.cat([torch.sin(ang_k), torch.sin(ang_k)], dim=-1)
    qc = torch.cat([torch.cos(ang_q), torch.cos(ang_q)], dim=-1)
    qs = torch.cat([torch.sin(ang_q), torch.sin(ang_q)], dim=-1)
    qk_i = torch.randint(0, qmax + 1, (B, H, Skv, Dh)).to(torch.int32)
    qv_i = torch.randint(0, qmax + 1, (B, H, Skv, Dh)).to(torch.int32)
    ksc = torch.abs((lambda *s: torch.randn(*s, dtype=torch.bfloat16) * 0.4)(B, H, Skv, ng)) * 0.1 + 0.01
    kzp = torch.full((B, H, Skv, ng), qmax / 2.0)
    vsc = torch.abs((lambda *s: torch.randn(*s, dtype=torch.bfloat16) * 0.4)(B, H, Skv, ng)) * 0.1 + 0.01
    vzp = torch.full((B, H, Skv, ng), qmax / 2.0)
    return {'q': _w((lambda *s: torch.randn(*s, dtype=torch.bfloat16) * 12.8)(B, H, Sq, Dh) * 0.5), 'qk': _w(qk_i), 'k_scales': _w(ksc), 'k_zeros': _w(kzp), 'qv': _w(qv_i), 'v_scales': _w(vsc), 'v_zeros': _w(vzp), 'q_cos': _w(qc), 'q_sin': _w(qs), 'k_cos': _w(kc), 'k_sin': _w(ks)}

def reference(q, qk, k_scales, k_zeros, qv, v_scales, v_zeros, q_cos, q_sin, k_cos, k_sin):
    B, H, Sq, Dh = q.shape
    ng = k_scales.shape[-1]
    G = Dh // ng
    half = Dh // 2
    ks = (lambda x, n, axis: torch.repeat_interleave(x, n, dim=axis))(k_scales, G, axis=-1)
    kz = (lambda x, n, axis: torch.repeat_interleave(x, n, dim=axis))(k_zeros, G, axis=-1)
    k = ((lambda x, dt: x.to(dt))(qk, q.dtype) - kz) * ks
    vs = (lambda x, n, axis: torch.repeat_interleave(x, n, dim=axis))(v_scales, G, axis=-1)
    vz = (lambda x, n, axis: torch.repeat_interleave(x, n, dim=axis))(v_zeros, G, axis=-1)
    v = ((lambda x, dt: x.to(dt))(qv, q.dtype) - vz) * vs
    k1 = k[..., :half].clone()
    k2 = k[..., half:].clone()
    krh = torch.concatenate([-k2, k1], axis=-1)
    kr = k * k_cos[None, None, :, :] + krh * k_sin[None, None, :, :]
    q1 = q[..., :half].clone()
    q2 = q[..., half:].clone()
    qrh = torch.concatenate([-q2, q1], axis=-1)
    qr = q * q_cos[None, None, :, :] + qrh * q_sin[None, None, :, :]
    logits = torch.einsum('bhqd,bhkd->bhqk', qr, kr) * float(Dh) ** (-0.5)
    attn = _softmax(logits, axis=-1)
    out = torch.einsum('bhqk,bhkd->bhqd', attn, v)
    return out
```

```asm
; @launch grid=(256,1,1) block=(512,1,1) lds=32768
.amdgcn_target "amdgcn-amd-amdhsa--gfx950"
.text
.globl standalone__kv_cache_quant_pre_rope_vs_post_rope__decode_kernel
.p2align 8
.type standalone__kv_cache_quant_pre_rope_vs_post_rope__decode_kernel,@function
standalone__kv_cache_quant_pre_rope_vs_post_rope__decode_kernel:
s_load_dwordx16 s[60:75], s[0:1], 0
s_load_dwordx8 s[76:83], s[0:1], 64
s_load_dwordx4 s[84:87], s[0:1], 96
s_cmp_ge_u32 s2, 256
s_cbranch_scc1 L_end
v_lshrrev_b32 v9, 6, v0
v_and_b32 v11, 15, v0
v_readfirstlane_b32 s88, v9
v_bfe_u32 v12, v0, 4, 2
s_mov_b32 s3, s2
s_bfe_u32 s93, s3, 0x30000
s_bfe_u32 s89, s3, 0x20003
s_bfe_u32 s94, s3, 0x30005
s_lshl_b32 s90, s94, 3
s_add_u32 s90, s90, s93
s_mov_b32 s6, 0x4000000
s_mov_b32 s7, 0x20000
s_mov_b32 s10, 0x4000000
s_mov_b32 s11, 0x20000
s_bfe_u32 s98, s88, 0x10001
s_lshl_b32 s97, s98, 3
s_bfe_u32 s98, s88, 0x10000
s_lshl_b32 s98, s98, 5
s_or_b32 s97, s97, s98
s_bfe_u32 s98, s94, 0x10001
s_lshl_b32 s98, s98, 6
s_or_b32 s97, s97, s98
s_bfe_u32 s98, s93, 0x10002
s_lshl_b32 s98, s98, 7
s_or_b32 s97, s97, s98
s_bfe_u32 s98, s93, 0x10001
s_lshl_b32 s98, s98, 8
s_or_b32 s97, s97, s98
s_bfe_u32 s98, s88, 0x10002
s_lshl_b32 s98, s98, 9
s_or_b32 s97, s97, s98
s_bfe_u32 s98, s93, 0x10000
s_lshl_b32 s98, s98, 10
s_or_b32 s97, s97, s98
s_bfe_u32 s98, s94, 0x10002
s_lshl_b32 s98, s98, 11
s_or_b32 s97, s97, s98
s_bfe_u32 s98, s94, 0x10000
s_lshl_b32 s98, s98, 12
s_or_b32 s97, s97, s98
v_lshlrev_b32 v13, 4, v11
v_lshl_add_u32 v10, v12, 22, v13
v_lshlrev_b32 v42, 1, v12
v_mov_b32 v43, 108
v_lshrrev_b32 v42, v42, v43
v_and_b32 v42, 3, v42
v_xor_b32 v40, 0, v42
v_and_b32 v41, 1, v40
v_lshl_add_u32 v1, v41, 13, v10
v_lshrrev_b32 v41, 1, v40
v_lshl_add_u32 v1, v41, 11, v1
v_xor_b32 v40, 1, v42
v_and_b32 v41, 1, v40
v_lshl_add_u32 v2, v41, 13, v10
v_lshrrev_b32 v41, 1, v40
v_lshl_add_u32 v2, v41, 11, v2
s_lshl_b32 s91, s89, 24
s_lshl_b32 s93, s97, 9
s_add_u32 s91, s91, s93
s_waitcnt lgkmcnt(0)
s_mov_b64 s[4:5], s[62:63]
s_mov_b64 s[8:9], s[68:69]
buffer_load_dwordx4 v[100:103], v1, s[4:7], s91 offen offset:0 nt
buffer_load_dwordx4 v[104:107], v1, s[4:7], s91 offen offset:256 nt
buffer_load_dwordx4 v[108:111], v1, s[4:7], s91 offen offset:512 nt
buffer_load_dwordx4 v[112:115], v1, s[4:7], s91 offen offset:768 nt
buffer_load_dwordx4 v[116:119], v1, s[4:7], s91 offen offset:1024 nt
buffer_load_dwordx4 v[120:123], v1, s[4:7], s91 offen offset:1280 nt
buffer_load_dwordx4 v[124:127], v1, s[4:7], s91 offen offset:1536 nt
buffer_load_dwordx4 v[128:131], v1, s[4:7], s91 offen offset:1792 nt
s_mov_b32 s22, 0x1000
s_mov_b32 s23, 0x20000
s_mov_b32 s42, 0x100
s_mov_b32 s43, 0x20000
s_mov_b32 s46, 0x100
s_mov_b32 s47, 0x20000
s_mov_b32 s26, 0x80000
s_mov_b32 s27, 0x20000
s_mov_b32 s30, 0x80000
s_mov_b32 s31, 0x20000
s_mov_b32 s34, 0x80000
s_mov_b32 s35, 0x20000
s_mov_b32 s38, 0x80000
s_mov_b32 s39, 0x20000
v_lshlrev_b32 v37, 3, v11
v_lshl_add_u32 v36, v12, 8, v37
v_bfrev_b32 v39, v11
v_lshrrev_b32 v39, 28, v39
v_lshlrev_b32 v40, 2, v42
v_xor_b32 v39, v39, v40
v_and_b32 v14, 3, v39
v_lshlrev_b32 v14, 2, v14
v_bfe_u32 v40, v39, 2, 1
v_lshl_add_u32 v14, v40, 6, v14
v_lshrrev_b32 v40, 3, v39
v_lshl_add_u32 v14, v40, 4, v14
v_lshl_add_u32 v14, v12, 15, v14
s_lshl_b32 s99, s89, 17
s_lshl_b32 s93, s97, 2
s_add_u32 s99, s99, s93
s_lshl_b32 s98, s89, 10
s_mov_b64 s[20:21], s[60:61]
s_mov_b64 s[40:41], s[74:75]
s_mov_b64 s[44:45], s[76:77]
s_mov_b64 s[24:25], s[64:65]
s_mov_b64 s[28:29], s[66:67]
s_mov_b64 s[32:33], s[70:71]
s_mov_b64 s[36:37], s[72:73]
buffer_load_dwordx2 v[16:17], v36, s[20:23], s98 offen
buffer_load_dwordx2 v[18:19], v36, s[20:23], s98 offen offset:128
buffer_load_dwordx2 v[28:29], v37, s[40:43], 0 offen
buffer_load_dwordx2 v[30:31], v37, s[40:43], 0 offen offset:128
buffer_load_dwordx2 v[32:33], v37, s[44:47], 0 offen
buffer_load_dwordx2 v[34:35], v37, s[44:47], 0 offen offset:128
buffer_load_dword v47, v14, s[24:27], s99 offen
buffer_load_dword v45, v14, s[28:31], s99 offen
buffer_load_dword v51, v14, s[32:35], s99 offen
buffer_load_dword v49, v14, s[36:39], s99 offen
buffer_load_dwordx4 v[132:135], v2, s[4:7], s91 offen offset:0 nt
buffer_load_dwordx4 v[136:139], v2, s[4:7], s91 offen offset:256 nt
buffer_load_dwordx4 v[140:143], v2, s[4:7], s91 offen offset:512 nt
buffer_load_dwordx4 v[144:147], v2, s[4:7], s91 offen offset:768 nt
buffer_load_dwordx4 v[148:151], v2, s[4:7], s91 offen offset:1024 nt
buffer_load_dwordx4 v[152:155], v2, s[4:7], s91 offen offset:1280 nt
buffer_load_dwordx4 v[156:159], v2, s[4:7], s91 offen offset:1536 nt
buffer_load_dwordx4 v[160:163], v2, s[4:7], s91 offen offset:1792 nt
buffer_load_dwordx4 v[164:167], v1, s[8:11], s91 offen offset:0 nt
buffer_load_dwordx4 v[168:171], v1, s[8:11], s91 offen offset:256 nt
buffer_load_dwordx4 v[172:175], v1, s[8:11], s91 offen offset:512 nt
buffer_load_dwordx4 v[176:179], v1, s[8:11], s91 offen offset:768 nt
buffer_load_dwordx4 v[180:183], v1, s[8:11], s91 offen offset:1024 nt
buffer_load_dwordx4 v[184:187], v1, s[8:11], s91 offen offset:1280 nt
buffer_load_dwordx4 v[188:191], v1, s[8:11], s91 offen offset:1536 nt
buffer_load_dwordx4 v[192:195], v1, s[8:11], s91 offen offset:1792 nt
s_mov_b32 s50, 0x1000
s_mov_b32 s51, 0x20000
s_mov_b32 s54, 0x100
s_mov_b32 s55, 0x20000
s_mov_b32 s58, 0x8a000
s_mov_b32 s59, 0x20000
v_xor_b32 v40, 2, v42
v_and_b32 v41, 1, v40
v_lshl_add_u32 v3, v41, 13, v10
v_lshrrev_b32 v41, 1, v40
v_lshl_add_u32 v3, v41, 11, v3
v_xor_b32 v40, 3, v42
v_and_b32 v41, 1, v40
v_lshl_add_u32 v4, v41, 13, v10
v_lshrrev_b32 v41, 1, v40
v_lshl_add_u32 v4, v41, 11, v4
s_lshl_b32 s101, s88, 12
v_add_u32 v9, s101, v13
v_xor_b32 v40, 0, v42
v_lshl_add_u32 v5, v40, 10, v9
v_xor_b32 v40, 1, v42
v_lshl_add_u32 v6, v40, 10, v9
v_xor_b32 v40, 2, v42
v_lshl_add_u32 v7, v40, 10, v9
v_xor_b32 v40, 3, v42
v_lshl_add_u32 v8, v40, 10, v9
s_lshl_b32 s92, s89, 6
s_add_u32 s92, s92, s90
s_mul_i32 s92, s92, 2176
s_lshl_b32 s95, s89, 11
s_lshl_b32 s96, s90, 3
s_add_u32 s95, s95, s96
s_add_u32 s95, s95, 557056
s_lshl_b32 s96, s89, 6
s_mov_b64 s[56:57], s[86:87]
s_mov_b64 s[48:49], s[82:83]
s_mov_b64 s[52:53], s[84:85]
s_cmp_lg_u32 s88, 7
s_cbranch_scc1 L_nomark
v_and_b32 v13, 63, v0
v_lshlrev_b32 v95, 4, v13
v_mov_b32 v76, -1
v_mov_b32 v77, -1
v_mov_b32 v78, -1
v_mov_b32 v79, -1
buffer_store_dwordx4 v[76:79], v95, s[56:59], s92 offen sc1
buffer_store_dwordx4 v[76:79], v95, s[56:59], s92 offen offset:1024 sc1
v_lshlrev_b32 v13, 5, v95
s_mov_b64 exec, 15
buffer_store_dwordx2 v[76:77], v13, s[56:59], s95 offen sc1
s_mov_b64 exec, -1
s_nop 1
L_nomark:
v_lshlrev_b32 v92, 4, v11
v_lshl_add_u32 v92, v12, 9, v92
v_add_u32 v92, s101, v92
v_lshlrev_b32 v93, 3, v12
v_add_u32 v93, 2048, v93
v_add_u32 v93, s101, v93
v_and_b32 v13, 63, v0
v_lshlrev_b32 v13, 2, v13
s_lshl_b32 s68, s88, 8
v_add_u32 v95, s68, v13
s_lshr_b32 s69, s88, 1
s_lshl_b32 s68, s69, 3
s_add_u32 s68, s68, 2048
v_mov_b32 v94, s68
v_and_b32 v13, 7, v0
v_lshl_add_u32 v94, v13, 12, v94
s_lshl_b32 s68, s69, 9
s_add_u32 s95, s95, s68
s_mov_b32 s84, 0
v_mov_b32 v90, 1
v_mov_b32 v96, 0
v_mov_b32 v97, 0
v_mov_b32 v98, 0
v_mov_b32 v99, 0
s_mov_b32 s60, 0x00010001
s_mov_b32 s61, 0x00010001
s_lshl_b64 exec, s[60:61], 0
v_mov_b32 v24, 0x3f800000
v_mov_b32 v25, 0x3f5dafd7
v_mov_b32 v26, 0x3f3ff911
v_mov_b32 v27, 0x3f263de0
s_lshl_b64 exec, s[60:61], 1
v_mov_b32 v24, 0x3f0ff59a
v_mov_b32 v25, 0x3ef953cf
v_mov_b32 v26, 0x3ed7e89b
v_mov_b32 v27, 0x3ebaf81b
s_lshl_b64 exec, s[60:61], 2
v_mov_b32 v24, 0x3ea1e89b
v_mov_b32 v25, 0x3e8c3504
v_mov_b32 v26, 0x3e72d423
v_mov_b32 v27, 0x3e5247ed
s_lshl_b64 exec, s[60:61], 3
v_mov_b32 v24, 0x3e361887
v_mov_b32 v25, 0x3e1db040
v_mov_b32 v26, 0x3e088d77
v_mov_b32 v27, 0x3dec7fd6
s_lshl_b64 exec, s[60:61], 4
v_mov_b32 v24, 0x3dcccccd
v_mov_b32 v25, 0x3db15978
v_mov_b32 v26, 0x3d99940d
v_mov_b32 v27, 0x3d84fe4d
s_lshl_b64 exec, s[60:61], 5
v_mov_b32 v24, 0x3d6655c2
v_mov_b32 v25, 0x3d47763f
v_mov_b32 v26, 0x3d2cba15
v_mov_b32 v27, 0x3d159348
s_lshl_b64 exec, s[60:61], 6
v_mov_b32 v24, 0x3d0186e3
v_mov_b32 v25, 0x3ce054d2
v_mov_b32 v26, 0x3cc2434f
v_mov_b32 v27, 0x3ca8398b
s_lshl_b64 exec, s[60:61], 7
v_mov_b32 v24, 0x3c91ad39
v_mov_b32 v25, 0x3c7c4d33
v_mov_b32 v26, 0x3c5a7bf2
v_mov_b32 v27, 0x3c3d3311
s_lshl_b64 exec, s[60:61], 8
v_mov_b32 v24, 0x3c23d70a
v_mov_b32 v25, 0x3c0de12d
v_mov_b32 v26, 0x3bf5b9b0
v_mov_b32 v27, 0x3bd4ca15
s_lshl_b64 exec, s[60:61], 9
v_mov_b32 v24, 0x3bb8449c
v_mov_b32 v25, 0x3b9f91cc
v_mov_b32 v26, 0x3b8a2e77
v_mov_b32 v27, 0x3b6f520e
s_lshl_b64 exec, s[60:61], 10
v_mov_b32 v24, 0x3b4f3e38
v_mov_b32 v25, 0x3b33770f
v_mov_b32 v26, 0x3b1b690d
v_mov_b32 v27, 0x3b06946f
s_lshl_b64 exec, s[60:61], 11
v_mov_b32 v24, 0x3ae91528
v_mov_b32 v25, 0x3ac9d75c
v_mov_b32 v26, 0x3aaec98e
v_mov_b32 v27, 0x3a975c0e
s_lshl_b64 exec, s[60:61], 12
v_mov_b32 v24, 0x3a83126f
v_mov_b32 v25, 0x3a6301e2
v_mov_b32 v26, 0x3a44948c
v_mov_b32 v27, 0x3a2a3b44
s_lshl_b64 exec, s[60:61], 13
v_mov_b32 v24, 0x3a136a16
v_mov_b32 v25, 0x39ff4fac
v_mov_b32 v26, 0x39dd1725
v_mov_b32 v27, 0x39bf74d7
s_lshl_b64 exec, s[60:61], 14
v_mov_b32 v24, 0x39a5cb60
v_mov_b32 v25, 0x398f9272
v_mov_b32 v26, 0x3978a815
v_mov_b32 v27, 0x395753e4
s_lshl_b64 exec, s[60:61], 15
v_mov_b32 v24, 0x393a7753
v_mov_b32 v25, 0x39217916
v_mov_b32 v26, 0x390bd472
v_mov_b32 v27, 0x38f22ce2
s_mov_b64 exec, -1
s_mov_b32 s62, 0x3e22f983
s_mov_b32 s63, 0x31dc9c88
v_lshlrev_b32 v10, 4, v11
v_lshl_add_u32 v10, v12, 8, v10
v_add_u32 v10, s101, v10
s_add_u32 s93, s97, 0
v_add_u32 v9, s93, v12
v_cvt_f32_u32 v9, v9
v_mul_f32 v52, v9, v24
v_mul_f32 v53, v9, v25
v_mul_f32 v54, v9, v26
v_mul_f32 v55, v9, v27
v_mul_f32 v63, s62, v52
v_mul_f32 v64, s62, v53
v_mul_f32 v65, s62, v54
v_mul_f32 v66, s62, v55
v_rndne_f32 v63, v63
v_rndne_f32 v64, v64
v_rndne_f32 v65, v65
v_rndne_f32 v66, v66
v_fma_f32 v67, v52, s62, -v63
v_fma_f32 v68, v53, s62, -v64
v_fma_f32 v69, v54, s62, -v65
v_fma_f32 v70, v55, s62, -v66
v_fma_f32 v67, v52, s63, v67
v_fma_f32 v68, v53, s63, v68
v_fma_f32 v69, v54, s63, v69
v_fma_f32 v70, v55, s63, v70
v_cos_f32 v52, v67
v_sin_f32 v63, v67
v_cos_f32 v53, v68
v_sin_f32 v64, v68
v_cos_f32 v54, v69
v_sin_f32 v65, v69
v_cos_f32 v55, v70
v_sin_f32 v66, v70
v_cvt_pk_bf16_f32 v72, v52, v63
v_cvt_pk_bf16_f32 v73, v53, v64
v_cvt_pk_bf16_f32 v74, v54, v65
v_cvt_pk_bf16_f32 v75, v55, v66
ds_write_b128 v10, v[72:75] offset:0
s_add_u32 s93, s97, 16
v_add_u32 v9, s93, v12
v_cvt_f32_u32 v9, v9
v_mul_f32 v52, v9, v24
v_mul_f32 v53, v9, v25
v_mul_f32 v54, v9, v26
v_mul_f32 v55, v9, v27
v_mul_f32 v63, s62, v52
v_mul_f32 v64, s62, v53
v_mul_f32 v65, s62, v54
v_mul_f32 v66, s62, v55
v_rndne_f32 v63, v63
v_rndne_f32 v64, v64
v_rndne_f32 v65, v65
v_rndne_f32 v66, v66
v_fma_f32 v67, v52, s62, -v63
v_fma_f32 v68, v53, s62, -v64
v_fma_f32 v69, v54, s62, -v65
v_fma_f32 v70, v55, s62, -v66
v_fma_f32 v67, v52, s63, v67
v_fma_f32 v68, v53, s63, v68
v_fma_f32 v69, v54, s63, v69
v_fma_f32 v70, v55, s63, v70
v_cos_f32 v52, v67
v_sin_f32 v63, v67
v_cos_f32 v53, v68
v_sin_f32 v64, v68
v_cos_f32 v54, v69
v_sin_f32 v65, v69
v_cos_f32 v55, v70
v_sin_f32 v66, v70
v_cvt_pk_bf16_f32 v72, v52, v63
v_cvt_pk_bf16_f32 v73, v53, v64
v_cvt_pk_bf16_f32 v74, v54, v65
v_cvt_pk_bf16_f32 v75, v55, v66
ds_write_b128 v10, v[72:75] offset:1024
s_add_u32 s93, s97, 4
v_add_u32 v9, s93, v12
v_cvt_f32_u32 v9, v9
v_mul_f32 v52, v9, v24
v_mul_f32 v53, v9, v25
v_mul_f32 v54, v9, v26
v_mul_f32 v55, v9, v27
v_mul_f32 v63, s62, v52
v_mul_f32 v64, s62, v53
v_mul_f32 v65, s62, v54
v_mul_f32 v66, s62, v55
v_rndne_f32 v63, v63
v_rndne_f32 v64, v64
v_rndne_f32 v65, v65
v_rndne_f32 v66, v66
v_fma_f32 v67, v52, s62, -v63
v_fma_f32 v68, v53, s62, -v64
v_fma_f32 v69, v54, s62, -v65
v_fma_f32 v70, v55, s62, -v66
v_fma_f32 v67, v52, s63, v67
v_fma_f32 v68, v53, s63, v68
v_fma_f32 v69, v54, s63, v69
v_fma_f32 v70, v55, s63, v70
v_cos_f32 v52, v67
v_sin_f32 v63, v67
v_cos_f32 v53, v68
v_sin_f32 v64, v68
v_cos_f32 v54, v69
v_sin_f32 v65, v69
v_cos_f32 v55, v70
v_sin_f32 v66, v70
v_cvt_pk_bf16_f32 v72, v52, v63
v_cvt_pk_bf16_f32 v73, v53, v64
v_cvt_pk_bf16_f32 v74, v54, v65
v_cvt_pk_bf16_f32 v75, v55, v66
ds_write_b128 v10, v[72:75] offset:2048
s_add_u32 s93, s97, 20
v_add_u32 v9, s93, v12
v_cvt_f32_u32 v9, v9
v_mul_f32 v52, v9, v24
v_mul_f32 v53, v9, v25
v_mul_f32 v54, v9, v26
v_mul_f32 v55, v9, v27
v_mul_f32 v63, s62, v52
v_mul_f32 v64, s62, v53
v_mul_f32 v65, s62, v54
v_mul_f32 v66, s62, v55
v_rndne_f32 v63, v63
v_rndne_f32 v64, v64
v_rndne_f32 v65, v65
v_rndne_f32 v66, v66
v_fma_f32 v67, v52, s62, -v63
v_fma_f32 v68, v53, s62, -v64
v_fma_f32 v69, v54, s62, -v65
v_fma_f32 v70, v55, s62, -v66
v_fma_f32 v67, v52, s63, v67
v_fma_f32 v68, v53, s63, v68
v_fma_f32 v69, v54, s63, v69
v_fma_f32 v70, v55, s63, v70
v_cos_f32 v52, v67
v_sin_f32 v63, v67
v_cos_f32 v53, v68
v_sin_f32 v64, v68
v_cos_f32 v54, v69
v_sin_f32 v65, v69
v_cos_f32 v55, v70
v_sin_f32 v66, v70
v_cvt_pk_bf16_f32 v72, v52, v63
v_cvt_pk_bf16_f32 v73, v53, v64
v_cvt_pk_bf16_f32 v74, v54, v65
v_cvt_pk_bf16_f32 v75, v55, v66
ds_write_b128 v10, v[72:75] offset:3072
s_waitcnt vmcnt(20)
v_lshlrev_b32 v76, 16, v16
v_lshlrev_b32 v77, 16, v18
v_lshlrev_b32 v78, 16, v28
v_lshlrev_b32 v79, 16, v30
v_lshlrev_b32 v80, 16, v32
v_lshlrev_b32 v81, 16, v34
v_mul_f32 v82, v76, v78
v_mul_f32 v83, v77, v80
v_mul_f32 v52, v77, v79
v_mul_f32 v53, v76, v81
v_cvt_pk_bf16_f32 v82, v82, v83
v_cvt_pk_bf16_f32 v52, v52, v53
v_and_b32 v83, 0xffff0000, v82
v_lshlrev_b32 v82, 16, v82
v_and_b32 v53, 0xffff0000, v52
v_lshlrev_b32 v52, 16, v52
v_sub_f32 v40, v82, v83
v_add_f32 v86, v52, v53
v_and_b32 v76, 0xffff0000, v16
v_and_b32 v77, 0xffff0000, v18
v_and_b32 v78, 0xffff0000, v28
v_and_b32 v79, 0xffff0000, v30
v_and_b32 v80, 0xffff0000, v32
v_and_b32 v81, 0xffff0000, v34
v_mul_f32 v82, v76, v78
v_mul_f32 v83, v77, v80
v_mul_f32 v52, v77, v79
v_mul_f32 v53, v76, v81
v_cvt_pk_bf16_f32 v82, v82, v83
v_cvt_pk_bf16_f32 v52, v52, v53
v_and_b32 v83, 0xffff0000, v82
v_lshlrev_b32 v82, 16, v82
v_and_b32 v53, 0xffff0000, v52
v_lshlrev_b32 v52, 16, v52
v_sub_f32 v41, v82, v83
v_add_f32 v87, v52, v53
v_lshlrev_b32 v76, 16, v17
v_lshlrev_b32 v77, 16, v19
v_lshlrev_b32 v78, 16, v29
v_lshlrev_b32 v79, 16, v31
v_lshlrev_b32 v80, 16, v33
v_lshlrev_b32 v81, 16, v35
v_mul_f32 v82, v76, v78
v_mul_f32 v83, v77, v80
v_mul_f32 v52, v77, v79
v_mul_f32 v53, v76, v81
v_cvt_pk_bf16_f32 v82, v82, v83
v_cvt_pk_bf16_f32 v52, v52, v53
v_and_b32 v83, 0xffff0000, v82
v_lshlrev_b32 v82, 16, v82
v_and_b32 v53, 0xffff0000, v52
v_lshlrev_b32 v52, 16, v52
v_sub_f32 v42, v82, v83
v_add_f32 v54, v52, v53
v_and_b32 v76, 0xffff0000, v17
v_and_b32 v77, 0xffff0000, v19
v_and_b32 v78, 0xffff0000, v29
v_and_b32 v79, 0xffff0000, v31
v_and_b32 v80, 0xffff0000, v33
v_and_b32 v81, 0xffff0000, v35
v_mul_f32 v82, v76, v78
v_mul_f32 v83, v77, v80
v_mul_f32 v52, v77, v79
v_mul_f32 v53, v76, v81
v_cvt_pk_bf16_f32 v82, v82, v83
v_cvt_pk_bf16_f32 v52, v52, v53
v_and_b32 v83, 0xffff0000, v82
v_lshlrev_b32 v82, 16, v82
v_and_b32 v53, 0xffff0000, v52
v_lshlrev_b32 v52, 16, v52
v_sub_f32 v43, v82, v83
v_add_f32 v55, v52, v53
v_cvt_pk_bf16_f32 v16, v40, v86
v_cvt_pk_bf16_f32 v20, v86, -v40
v_cvt_pk_bf16_f32 v17, v41, v87
v_cvt_pk_bf16_f32 v21, v87, -v41
v_cvt_pk_bf16_f32 v18, v42, v54
v_cvt_pk_bf16_f32 v22, v54, -v42
v_cvt_pk_bf16_f32 v19, v43, v55
v_cvt_pk_bf16_f32 v23, v55, -v43
s_waitcnt vmcnt(16)
v_lshlrev_b32 v46, 16, v47
v_and_b32 v47, 0xffff0000, v47
v_lshlrev_b32 v44, 16, v45
v_and_b32 v45, 0xffff0000, v45
v_lshlrev_b32 v50, 16, v51
v_and_b32 v51, 0xffff0000, v51
v_lshlrev_b32 v48, 16, v49
v_and_b32 v49, 0xffff0000, v49
s_mov_b32 s60, 0xcccccccc
s_mov_b32 s61, 0xcccccccc
s_waitcnt lgkmcnt(0)
ds_read_b128 v[28:31], v5 offset:0
s_waitcnt lgkmcnt(0)
v_dot2_f32_bf16 v40, v28, v20, 0
v_dot2_f32_bf16 v41, v29, v21, 0
v_dot2_f32_bf16 v42, v30, v22, 0
v_dot2_f32_bf16 v43, v31, v23, 0
v_dot2_f32_bf16 v36, v28, v16, 0
v_dot2_f32_bf16 v37, v29, v17, 0
v_dot2_f32_bf16 v38, v30, v18, 0
v_dot2_f32_bf16 v39, v31, v19, 0
ds_read_b128 v[28:31], v5 offset:256
v_mov_b32_dpp v56, v44 row_newbcast:0 row_mask:0xf bank_mask:0xf
v_mov_b32_dpp v57, v45 row_newbcast:0 row_mask:0xf bank_mask:0xf
s_waitcnt vmcnt(32)
v_cvt_f32_i32 v100, v100
v_cvt_f32_i32 v101, v101
v_cvt_f32_i32 v102, v102
v_cvt_f32_i32 v103, v103
v_cvt_f32_i32 v104, v104
v_cvt_f32_i32 v105, v105
v_cvt_f32_i32 v106, v106
v_cvt_f32_i32 v107, v107
v_pk_add_f32 v[100:101], v[100:101], v[56:57] op_sel:[0,0] op_sel_hi:[1,0] neg_lo:[0,1] neg_hi:[0,1]
v_pk_add_f32 v[102:103], v[102:103], v[56:57] op_sel:[0,0] op_sel_hi:[1,0] neg_lo:[0,1] neg_hi:[0,1]
v_pk_add_f32 v[104:105], v[104:105], v[56:57] op_sel:[0,1] op_sel_hi:[1,1] neg_lo:[0,1] neg_hi:[0,1]
v_pk_add_f32 v[106:107], v[106:107], v[56:57] op_sel:[0,1] op_sel_hi:[1,1] neg_lo:[0,1] neg_hi:[0,1]
v_pk_mul_f32 v[58:59], v[100:101], v[36:37]
v_pk_mul_f32 v[60:61], v[104:105], v[40:41]
v_pk_fma_f32 v[58:59], v[102:103], v[38:39], v[58:59]
v_pk_fma_f32 v[60:61], v[106:107], v[42:43], v[60:61]
v_add_f32 v52, v58, v59
v_add_f32 v53, v60, v61
buffer_load_dwordx4 v[100:103], v2, s[8:11], s91 offen offset:0 nt
buffer_load_dwordx4 v[104:107], v2, s[8:11], s91 offen offset:256 nt
v_mul_f32_dpp v63, v46, v52 row_newbcast:0 row_mask:0xf bank_mask:0xf
v_mul_f32_dpp v52, v47, v53 row_newbcast:0 row_mask:0xf bank_mask:0xf
v_add_f32 v63, v63, v52
s_waitcnt lgkmcnt(0)
v_dot2_f32_bf16 v40, v28, v20, 0
v_dot2_f32_bf16 v41, v29, v21, 0
v_dot2_f32_bf16 v42, v30, v22, 0
v_dot2_f32_bf16 v43, v31, v23, 0
v_dot2_f32_bf16 v36, v28, v16, 0
v_dot2_f32_bf16 v37, v29, v17, 0
v_dot2_f32_bf16 v38, v30, v18, 0
v_dot2_f32_bf16 v39, v31, v19, 0
ds_read_b128 v[28:31], v5 offset:512
v_mov_b32_dpp v56, v44 row_newbcast:8 row_mask:0xf bank_mask:0xf
v_mov_b32_dpp v57, v45 row_newbcast:8 row_mask:0xf bank_mask:0xf
s_waitcnt vmcnt(32)
v_cvt_f32_i32 v108, v108
v_cvt_f32_i32 v109, v109
v_cvt_f32_i32 v110, v110
v_cvt_f32_i32 v111, v111
v_cvt_f32_i32 v112, v112
v_cvt_f32_i32 v113, v113
v_cvt_f32_i32 v114, v114
v_cvt_f32_i32 v115, v115
v_pk_add_f32 v[108:109], v[108:109], v[56:57] op_sel:[0,0] op_sel_hi:[1,0] neg_lo:[0,1] neg_hi:[0,1]
v_pk_add_f32 v[110:111], v[110:111], v[56:57] op_sel:[0,0] op_sel_hi:[1,0] neg_lo:[0,1] neg_hi:[0,1]
v_pk_add_f32 v[112:113], v[112:113], v[56:57] op_sel:[0,1] op_sel_hi:[1,1] neg_lo:[0,1] neg_hi:[0,1]
v_pk_add_f32 v[114:115], v[114:115], v[56:57] op_sel:[0,1] op_sel_hi:[1,1] neg_lo:[0,1] neg_hi:[0,1]
v_pk_mul_f32 v[58:59], v[108:109], v[36:37]
v_pk_mul_f32 v[60:61], v[112:113], v[40:41]
v_pk_fma_f32 v[58:59], v[110:111], v[38:39], v[58:59]
v_pk_fma_f32 v[60:61], v[114:115], v[42:43], v[60:61]
v_add_f32 v52, v58, v59
v_add_f32 v53, v60, v61
buffer_load_dwordx4 v[108:111], v2, s[8:11], s91 offen offset:512 nt
buffer_load_dwordx4 v[112:115], v2, s[8:11], s91 offen offset:768 nt
v_mul_f32_dpp v64, v46, v52 row_newbcast:8 row_mask:0xf bank_mask:0xf
v_mul_f32_dpp v52, v47, v53 row_newbcast:8 row_mask:0xf bank_mask:0xf
v_add_f32 v64, v64, v52
s_waitcnt lgkmcnt(0)
v_dot2_f32_bf16 v40, v28, v20, 0
v_dot2_f32_bf16 v41, v29, v21, 0
v_add_f32_dpp v65, v63, v63 row_ror:8 row_mask:0xf bank_mask:0x3
v_dot2_f32_bf16 v42, v30, v22, 0
v_dot2_f32_bf16 v43, v31, v23, 0
v_add_f32_dpp v65, v64, v64 row_ror:8 row_mask:0xf bank_mask:0xc
v_dot2_f32_bf16 v36, v28, v16, 0
v_dot2_f32_bf16 v37, v29, v17, 0
v_dot2_f32_bf16 v38, v30, v18, 0
v_dot2_f32_bf16 v39, v31, v19, 0
ds_read_b128 v[28:31], v5 offset:768
v_mov_b32_dpp v56, v44 row_newbcast:4 row_mask:0xf bank_mask:0xf
v_mov_b32_dpp v57, v45 row_newbcast:4 row_mask:0xf bank_mask:0xf
s_waitcnt vmcnt(32)
v_cvt_f32_i32 v116, v116
v_cvt_f32_i32 v117, v117
v_cvt_f32_i32 v118, v118
v_cvt_f32_i32 v119, v119
v_cvt_f32_i32 v120, v120
v_cvt_f32_i32 v121, v121
v_cvt_f32_i32 v122, v122
v_cvt_f32_i32 v123, v123
v_pk_add_f32 v[116:117], v[116:117], v[56:57] op_sel:[0,0] op_sel_hi:[1,0] neg_lo:[0,1] neg_hi:[0,1]
v_pk_add_f32 v[118:119], v[118:119], v[56:57] op_sel:[0,0] op_sel_hi:[1,0] neg_lo:[0,1] neg_hi:[0,1]
v_pk_add_f32 v[120:121], v[120:121], v[56:57] op_sel:[0,1] op_sel_hi:[1,1] neg_lo:[0,1] neg_hi:[0,1]
v_pk_add_f32 v[122:123], v[122:123], v[56:57] op_sel:[0,1] op_sel_hi:[1,1] neg_lo:[0,1] neg_hi:[0,1]
v_pk_mul_f32 v[58:59], v[116:117], v[36:37]
v_pk_mul_f32 v[60:61], v[120:121], v[40:41]
v_pk_fma_f32 v[58:59], v[118:119], v[38:39], v[58:59]
v_pk_fma_f32 v[60:61], v[122:123], v[42:43], v[60:61]
v_add_f32 v52, v58, v59
v_add_f32 v53, v60, v61
buffer_load_dwordx4 v[116:119], v2, s[8:11], s91 offen offset:1024 nt
buffer_load_dwordx4 v[120:123], v2, s[8:11], s91 offen offset:1280 nt
v_mul_f32_dpp v63, v46, v52 row_newbcast:4 row_mask:0xf bank_mask:0xf
v_mul_f32_dpp v52, v47, v53 row_newbcast:4 row_mask:0xf bank_mask:0xf
v_add_f32 v63, v63, v52
s_waitcnt lgkmcnt(0)
v_dot2_f32_bf16 v40, v28, v20, 0
v_dot2_f32_bf16 v41, v29, v21, 0
v_dot2_f32_bf16 v42, v30, v22, 0
v_dot2_f32_bf16 v43, v31, v23, 0
v_dot2_f32_bf16 v36, v28, v16, 0
v_dot2_f32_bf16 v37, v29, v17, 0
v_dot2_f32_bf16 v38, v30, v18, 0
v_dot2_f32_bf16 v39, v31, v19, 0
ds_read_b128 v[28:31], v6 offset:0
v_mov_b32_dpp v56, v44 row_newbcast:12 row_mask:0xf bank_mask:0xf
v_mov_b32_dpp v57, v45 row_newbcast:12 row_mask:0xf bank_mask:0xf
s_waitcnt vmcnt(32)
v_cvt_f32_i32 v124, v124
v_cvt_f32_i32 v125, v125
v_cvt_f32_i32 v126, v126
v_cvt_f32_i32 v127, v127
v_cvt_f32_i32 v128, v128
v_cvt_f32_i32 v129, v129
v_cvt_f32_i32 v130, v130
v_cvt_f32_i32 v131, v131
v_pk_add_f32 v[124:125], v[124:125], v[56:57] op_sel:[0,0] op_sel_hi:[1,0] neg_lo:[0,1] neg_hi:[0,1]
v_pk_add_f32 v[126:127], v[126:127], v[56:57] op_sel:[0,0] op_sel_hi:[1,0] neg_lo:[0,1] neg_hi:[0,1]
v_pk_add_f32 v[128:129], v[128:129], v[56:57] op_sel:[0,1] op_sel_hi:[1,1] neg_lo:[0,1] neg_hi:[0,1]
v_pk_add_f32 v[130:131], v[130:131], v[56:57] op_sel:[0,1] op_sel_hi:[1,1] neg_lo:[0,1] neg_hi:[0,1]
v_pk_mul_f32 v[58:59], v[124:125], v[36:37]
v_pk_mul_f32 v[60:61], v[128:129], v[40:41]
v_pk_fma_f32 v[58:59], v[126:127], v[38:39], v[58:59]
v_pk_fma_f32 v[60:61], v[130:131], v[42:43], v[60:61]
v_add_f32 v52, v58, v59
v_add_f32 v53, v60, v61
buffer_load_dwordx4 v[124:127], v2, s[8:11], s91 offen offset:1536 nt
buffer_load_dwordx4 v[128:131], v2, s[8:11], s91 offen offset:1792 nt
v_mul_f32_dpp v64, v46, v52 row_newbcast:12 row_mask:0xf bank_mask:0xf
v_mul_f32_dpp v52, v47, v53 row_newbcast:12 row_mask:0xf bank_mask:0xf
v_add_f32 v64, v64, v52
s_waitcnt lgkmcnt(0)
v_dot2_f32_bf16 v40, v28, v20, 0
v_dot2_f32_bf16 v41, v29, v21, 0
v_add_f32_dpp v66, v63, v63 row_ror:8 row_mask:0xf bank_mask:0x3
v_dot2_f32_bf16 v42, v30, v22, 0
v_dot2_f32_bf16 v43, v31, v23, 0
v_add_f32_dpp v66, v64, v64 row_ror:8 row_mask:0xf bank_mask:0xc
v_dot2_f32_bf16 v36, v28, v16, 0
v_dot2_f32_bf16 v37, v29, v17, 0
v_add_f32_dpp v67, v65, v65 row_half_mirror row_mask:0xf bank_mask:0x5
v_dot2_f32_bf16 v38, v30, v18, 0
v_dot2_f32_bf16 v39, v31, v19, 0
v_add_f32_dpp v67, v66, v66 row_half_mirror row_mask:0xf bank_mask:0xa
ds_read_b128 v[28:31], v6 offset:256
v_mov_b32_dpp v56, v44 row_newbcast:2 row_mask:0xf bank_mask:0xf
v_mov_b32_dpp v57, v45 row_newbcast:2 row_mask:0xf bank_mask:0xf
s_waitcnt vmcnt(22)
v_cvt_f32_i32 v132, v132
v_cvt_f32_i32 v133, v133
v_cvt_f32_i32 v134, v134
v_cvt_f32_i32 v135, v135
v_cvt_f32_i32 v136, v136
v_cvt_f32_i32 v137, v137
v_cvt_f32_i32 v138, v138
v_cvt_f32_i32 v139, v139
v_pk_add_f32 v[132:133], v[132:133], v[56:57] op_sel:[0,0] op_sel_hi:[1,0] neg_lo:[0,1] neg_hi:[0,1]
v_pk_add_f32 v[134:135], v[134:135], v[56:57] op_sel:[0,0] op_sel_hi:[1,0] neg_lo:[0,1] neg_hi:[0,1]
v_pk_add_f32 v[136:137], v[136:137], v[56:57] op_sel:[0,1] op_sel_hi:[1,1] neg_lo:[0,1] neg_hi:[0,1]
v_pk_add_f32 v[138:139], v[138:139], v[56:57] op_sel:[0,1] op_sel_hi:[1,1] neg_lo:[0,1] neg_hi:[0,1]
v_pk_mul_f32 v[58:59], v[132:133], v[36:37]
v_pk_mul_f32 v[60:61], v[136:137], v[40:41]
v_pk_fma_f32 v[58:59], v[134:135], v[38:39], v[58:59]
v_pk_fma_f32 v[60:61], v[138:139], v[42:43], v[60:61]
v_add_f32 v52, v58, v59
v_add_f32 v53, v60, v61
buffer_load_dwordx4 v[132:135], v3, s[4:7], s91 offen offset:0 nt
buffer_load_dwordx4 v[136:139], v3, s[4:7], s91 offen offset:256 nt
v_mul_f32_dpp v63, v46, v52 row_newbcast:2 row_mask:0xf bank_mask:0xf
v_mul_f32_dpp v52, v47, v53 row_newbcast:2 row_mask:0xf bank_mask:0xf
v_add_f32 v63, v63, v52
s_waitcnt lgkmcnt(0)
v_dot2_f32_bf16 v40, v28, v20, 0
v_dot2_f32_bf16 v41, v29, v21, 0
v_dot2_f32_bf16 v42, v30, v22, 0
v_dot2_f32_bf16 v43, v31, v23, 0
v_dot2_f32_bf16 v36, v28, v16, 0
v_dot2_f32_bf16 v37, v29, v17, 0
v_dot2_f32_bf16 v38, v30, v18, 0
v_dot2_f32_bf16 v39, v31, v19, 0
ds_read_b128 v[28:31], v6 offset:512
v_mov_b32_dpp v56, v44 row_newbcast:10 row_mask:0xf bank_mask:0xf
v_mov_b32_dpp v57, v45 row_newbcast:10 row_mask:0xf bank_mask:0xf
s_waitcnt vmcnt(22)
v_cvt_f32_i32 v140, v140
v_cvt_f32_i32 v141, v141
v_cvt_f32_i32 v142, v142
v_cvt_f32_i32 v143, v143
v_cvt_f32_i32 v144, v144
v_cvt_f32_i32 v145, v145
v_cvt_f32_i32 v146, v146
v_cvt_f32_i32 v147, v147
v_pk_add_f32 v[140:141], v[140:141], v[56:57] op_sel:[0,0] op_sel_hi:[1,0] neg_lo:[0,1] neg_hi:[0,1]
v_pk_add_f32 v[142:143], v[142:143], v[56:57] op_sel:[0,0] op_sel_hi:[1,0] neg_lo:[0,1] neg_hi:[0,1]
v_pk_add_f32 v[144:145], v[144:145], v[56:57] op_sel:[0,1] op_sel_hi:[1,1] neg_lo:[0,1] neg_hi:[0,1]
v_pk_add_f32 v[146:147], v[146:147], v[56:57] op_sel:[0,1] op_sel_hi:[1,1] neg_lo:[0,1] neg_hi:[0,1]
v_pk_mul_f32 v[58:59], v[140:141], v[36:37]
v_pk_mul_f32 v[60:61], v[144:145], v[40:41]
v_pk_fma_f32 v[58:59], v[142:143], v[38:39], v[58:59]
v_pk_fma_f32 v[60:61], v[146:147], v[42:43], v[60:61]
v_add_f32 v52, v58, v59
v_add_f32 v53, v60, v61
buffer_load_dwordx4 v[140:143], v3, s[4:7], s91 offen offset:512 nt
buffer_load_dwordx4 v[144:147], v3, s[4:7], s91 offen offset:768 nt
v_mul_f32_dpp v64, v46, v52 row_newbcast:10 row_mask:0xf bank_mask:0xf
v_mul_f32_dpp v52, v47, v53 row_newbcast:10 row_mask:0xf bank_mask:0xf
v_add_f32 v64, v64, v52
s_waitcnt lgkmcnt(0)
v_dot2_f32_bf16 v40, v28, v20, 0
v_dot2_f32_bf16 v41, v29, v21, 0
v_add_f32_dpp v65, v63, v63 row_ror:8 row_mask:0xf bank_mask:0x3
v_dot2_f32_bf16 v42, v30, v22, 0
v_dot2_f32_bf16 v43, v31, v23, 0
v_add_f32_dpp v65, v64, v64 row_ror:8 row_mask:0xf bank_mask:0xc
v_dot2_f32_bf16 v36, v28, v16, 0
v_dot2_f32_bf16 v37, v29, v17, 0
v_dot2_f32_bf16 v38, v30, v18, 0
v_dot2_f32_bf16 v39, v31, v19, 0
ds_read_b128 v[28:31], v6 offset:768
v_mov_b32_dpp v56, v44 row_newbcast:6 row_mask:0xf bank_mask:0xf
v_mov_b32_dpp v57, v45 row_newbcast:6 row_mask:0xf bank_mask:0xf
s_waitcnt vmcnt(22)
v_cvt_f32_i32 v148, v148
v_cvt_f32_i32 v149, v149
v_cvt_f32_i32 v150, v150
v_cvt_f32_i32 v151, v151
v_cvt_f32_i32 v152, v152
v_cvt_f32_i32 v153, v153
v_cvt_f32_i32 v154, v154
v_cvt_f32_i32 v155, v155
v_pk_add_f32 v[148:149], v[148:149], v[56:57] op_sel:[0,0] op_sel_hi:[1,0] neg_lo:[0,1] neg_hi:[0,1]
v_pk_add_f32 v[150:151], v[150:151], v[56:57] op_sel:[0,0] op_sel_hi:[1,0] neg_lo:[0,1] neg_hi:[0,1]
v_pk_add_f32 v[152:153], v[152:153], v[56:57] op_sel:[0,1] op_sel_hi:[1,1] neg_lo:[0,1] neg_hi:[0,1]
v_pk_add_f32 v[154:155], v[154:155], v[56:57] op_sel:[0,1] op_sel_hi:[1,1] neg_lo:[0,1] neg_hi:[0,1]
v_pk_mul_f32 v[58:59], v[148:149], v[36:37]
v_pk_mul_f32 v[60:61], v[152:153], v[40:41]
v_pk_fma_f32 v[58:59], v[150:151], v[38:39], v[58:59]
v_pk_fma_f32 v[60:61], v[154:155], v[42:43], v[60:61]
v_add_f32 v52, v58, v59
v_add_f32 v53, v60, v61
buffer_load_dwordx4 v[148:151], v3, s[4:7], s91 offen offset:1024 nt
buffer_load_dwordx4 v[152:155], v3, s[4:7], s91 offen offset:1280 nt
v_mul_f32_dpp v63, v46, v52 row_newbcast:6 row_mask:0xf bank_mask:0xf
v_mul_f32_dpp v52, v47, v53 row_newbcast:6 row_mask:0xf bank_mask:0xf
v_add_f32 v63, v63, v52
s_waitcnt lgkmcnt(0)
v_dot2_f32_bf16 v40, v28, v20, 0
v_dot2_f32_bf16 v41, v29, v21, 0
v_dot2_f32_bf16 v42, v30, v22, 0
v_dot2_f32_bf16 v43, v31, v23, 0
v_dot2_f32_bf16 v36, v28, v16, 0
v_dot2_f32_bf16 v37, v29, v17, 0
v_dot2_f32_bf16 v38, v30, v18, 0
v_dot2_f32_bf16 v39, v31, v19, 0
ds_read_b128 v[28:31], v7 offset:0
v_mov_b32_dpp v56, v44 row_newbcast:14 row_mask:0xf bank_mask:0xf
v_mov_b32_dpp v57, v45 row_newbcast:14 row_mask:0xf bank_mask:0xf
s_waitcnt vmcnt(22)
v_cvt_f32_i32 v156, v156
v_cvt_f32_i32 v157, v157
v_cvt_f32_i32 v158, v158
v_cvt_f32_i32 v159, v159
v_cvt_f32_i32 v160, v160
v_cvt_f32_i32 v161, v161
v_cvt_f32_i32 v162, v162
v_cvt_f32_i32 v163, v163
v_pk_add_f32 v[156:157], v[156:157], v[56:57] op_sel:[0,0] op_sel_hi:[1,0] neg_lo:[0,1] neg_hi:[0,1]
v_pk_add_f32 v[158:159], v[158:159], v[56:57] op_sel:[0,0] op_sel_hi:[1,0] neg_lo:[0,1] neg_hi:[0,1]
v_pk_add_f32 v[160:161], v[160:161], v[56:57] op_sel:[0,1] op_sel_hi:[1,1] neg_lo:[0,1] neg_hi:[0,1]
v_pk_add_f32 v[162:163], v[162:163], v[56:57] op_sel:[0,1] op_sel_hi:[1,1] neg_lo:[0,1] neg_hi:[0,1]
v_pk_mul_f32 v[58:59], v[156:157], v[36:37]
v_pk_mul_f32 v[60:61], v[160:161], v[40:41]
v_pk_fma_f32 v[58:59], v[158:159], v[38:39], v[58:59]
v_pk_fma_f32 v[60:61], v[162:163], v[42:43], v[60:61]
v_add_f32 v52, v58, v59
v_add_f32 v53, v60, v61
buffer_load_dwordx4 v[156:159], v3, s[4:7], s91 offen offset:1536 nt
buffer_load_dwordx4 v[160:163], v3, s[4:7], s91 offen offset:1792 nt
v_mul_f32_dpp v64, v46, v52 row_newbcast:14 row_mask:0xf bank_mask:0xf
v_mul_f32_dpp v52, v47, v53 row_newbcast:14 row_mask:0xf bank_mask:0xf
v_add_f32 v64, v64, v52
v_add_f32_dpp v66, v63, v63 row_ror:8 row_mask:0xf bank_mask:0x3
s_nop 1
v_add_f32_dpp v66, v64, v64 row_ror:8 row_mask:0xf bank_mask:0xc
v_add_f32_dpp v68, v65, v65 row_half_mirror row_mask:0xf bank_mask:0x5
s_nop 1
v_add_f32_dpp v68, v66, v66 row_half_mirror row_mask:0xf bank_mask:0xa
v_add_f32_dpp v70, v67, v67 quad_perm:[2,3,0,1] row_mask:0xf bank_mask:0xf
s_nop 0
v_add_f32_dpp v71, v68, v68 quad_perm:[2,3,0,1] row_mask:0xf bank_mask:0xf
v_cndmask_b32 v69, v70, v71, s[60:61]
s_nop 1
v_add_f32_dpp v55, v69, v69 quad_perm:[1,0,3,2] row_mask:0xf bank_mask:0xf
v_mul_f32 v55, 0x3e0293ee, v55
s_nop 1
v_max_f32_dpp v86, v55, v55 row_ror:8 row_mask:0xf bank_mask:0xf
s_nop 1
v_max_f32_dpp v86, v86, v86 row_ror:4 row_mask:0xf bank_mask:0xf
s_nop 1
v_max_f32_dpp v86, v86, v86 row_ror:2 row_mask:0xf bank_mask:0xf
v_sub_f32 v71, v55, v86
v_exp_f32 v71, v71
s_mov_b32 s62, 0x55555555
s_mov_b32 s63, 0x55555555
v_cndmask_b32 v71, 0, v71, s[62:63]
v_mul_f32 v84, v71, v50
v_mul_f32 v85, v71, v51
v_mul_f32 v88, v84, v48
v_mul_f32 v89, v85, v49
v_add_f32_dpp v71, v71, v71 row_ror:8 row_mask:0xf bank_mask:0xf
v_add_f32_dpp v88, v88, v88 row_ror:8 row_mask:0xf bank_mask:0xf
v_add_f32_dpp v89, v89, v89 row_ror:8 row_mask:0xf bank_mask:0xf
v_add_f32_dpp v71, v71, v71 row_ror:4 row_mask:0xf bank_mask:0xf
v_add_f32_dpp v88, v88, v88 row_ror:4 row_mask:0xf bank_mask:0xf
v_add_f32_dpp v89, v89, v89 row_ror:4 row_mask:0xf bank_mask:0xf
v_add_f32_dpp v71, v71, v71 row_ror:2 row_mask:0xf bank_mask:0xf
v_add_f32_dpp v88, v88, v88 row_ror:2 row_mask:0xf bank_mask:0xf
v_add_f32_dpp v89, v89, v89 row_ror:2 row_mask:0xf bank_mask:0xf
v_add_f32_dpp v71, v71, v71 row_ror:1 row_mask:0xf bank_mask:0xf
v_add_f32_dpp v88, v88, v88 row_ror:1 row_mask:0xf bank_mask:0xf
v_add_f32_dpp v89, v89, v89 row_ror:1 row_mask:0xf bank_mask:0xf
v_mov_b32 v87, v71
v_sub_f32 v76, 0, v88
v_sub_f32 v77, 0, v88
v_sub_f32 v78, 0, v88
v_sub_f32 v79, 0, v88
v_sub_f32 v80, 0, v89
v_sub_f32 v81, 0, v89
v_sub_f32 v82, 0, v89
v_sub_f32 v83, 0, v89
v_mov_b32_dpp v56, v84 row_newbcast:0 row_mask:0xf bank_mask:0xf
v_mov_b32_dpp v57, v85 row_newbcast:0 row_mask:0xf bank_mask:0xf
s_waitcnt vmcnt(22)
v_cvt_f32_i32 v164, v164
v_cvt_f32_i32 v165, v165
v_cvt_f32_i32 v166, v166
v_cvt_f32_i32 v167, v167
v_cvt_f32_i32 v168, v168
v_cvt_f32_i32 v169, v169
v_cvt_f32_i32 v170, v170
v_cvt_f32_i32 v171, v171
v_pk_fma_f32 v[76:77], v[164:165], v[56:57], v[76:77] op_sel:[0,0,0] op_sel_hi:[1,0,1]
v_pk_fma_f32 v[78:79], v[166:167], v[56:57], v[78:79] op_sel:[0,0,0] op_sel_hi:[1,0,1]
v_pk_fma_f32 v[80:81], v[168:169], v[56:57], v[80:81] op_sel:[0,1,0] op_sel_hi:[1,1,1]
v_pk_fma_f32 v[82:83], v[170:171], v[56:57], v[82:83] op_sel:[0,1,0] op_sel_hi:[1,1,1]
buffer_load_dwordx4 v[164:167], v4, s[4:7], s91 offen offset:0 nt
buffer_load_dwordx4 v[168:171], v4, s[4:7], s91 offen offset:256 nt
v_mov_b32_dpp v56, v84 row_newbcast:8 row_mask:0xf bank_mask:0xf
v_mov_b32_dpp v57, v85 row_newbcast:8 row_mask:0xf bank_mask:0xf
s_waitcnt vmcnt(22)
v_cvt_f32_i32 v172, v172
v_cvt_f32_i32 v173, v173
v_cvt_f32_i32 v174, v174
v_cvt_f32_i32 v175, v175
v_cvt_f32_i32 v176, v176
v_cvt_f32_i32 v177, v177
v_cvt_f32_i32 v178, v178
v_cvt_f32_i32 v179, v179
v_pk_fma_f32 v[76:77], v[172:173], v[56:57], v[76:77] op_sel:[0,0,0] op_sel_hi:[1,0,1]
v_pk_fma_f32 v[78:79], v[174:175], v[56:57], v[78:79] op_sel:[0,0,0] op_sel_hi:[1,0,1]
v_pk_fma_f32 v[80:81], v[176:177], v[56:57], v[80:81] op_sel:[0,1,0] op_sel_hi:[1,1,1]
v_pk_fma_f32 v[82:83], v[178:179], v[56:57], v[82:83] op_sel:[0,1,0] op_sel_hi:[1,1,1]
buffer_load_dwordx4 v[172:175], v4, s[4:7], s91 offen offset:512 nt
buffer_load_dwordx4 v[176:179], v4, s[4:7], s91 offen offset:768 nt
v_mov_b32_dpp v56, v84 row_newbcast:4 row_mask:0xf bank_mask:0xf
v_mov_b32_dpp v57, v85 row_newbcast:4 row_mask:0xf bank_mask:0xf
s_waitcnt vmcnt(22)
v_cvt_f32_i32 v180, v180
v_cvt_f32_i32 v181, v181
v_cvt_f32_i32 v182, v182
v_cvt_f32_i32 v183, v183
v_cvt_f32_i32 v184, v184
v_cvt_f32_i32 v185, v185
v_cvt_f32_i32 v186, v186
v_cvt_f32_i32 v187, v187
v_pk_fma_f32 v[76:77], v[180:181], v[56:57], v[76:77] op_sel:[0,0,0] op_sel_hi:[1,0,1]
v_pk_fma_f32 v[78:79], v[182:183], v[56:57], v[78:79] op_sel:[0,0,0] op_sel_hi:[1,0,1]
v_pk_fma_f32 v[80:81], v[184:185], v[56:57], v[80:81] op_sel:[0,1,0] op_sel_hi:[1,1,1]
v_pk_fma_f32 v[82:83], v[186:187], v[56:57], v[82:83] op_sel:[0,1,0] op_sel_hi:[1,1,1]
buffer_load_dwordx4 v[180:183], v4, s[4:7], s91 offen offset:1024 nt
buffer_load_dwordx4 v[184:187], v4, s[4:7], s91 offen offset:1280 nt
v_mov_b32_dpp v56, v84 row_newbcast:12 row_mask:0xf bank_mask:0xf
v_mov_b32_dpp v57, v85 row_newbcast:12 row_mask:0xf bank_mask:0xf
s_waitcnt vmcnt(22)
v_cvt_f32_i32 v188, v188
v_cvt_f32_i32 v189, v189
v_cvt_f32_i32 v190, v190
v_cvt_f32_i32 v191, v191
v_cvt_f32_i32 v192, v192
v_cvt_f32_i32 v193, v193
v_cvt_f32_i32 v194, v194
v_cvt_f32_i32 v195, v195
v_pk_fma_f32 v[76:77], v[188:189], v[56:57], v[76:77] op_sel:[0,0,0] op_sel_hi:[1,0,1]
v_pk_fma_f32 v[78:79], v[190:191], v[56:57], v[78:79] op_sel:[0,0,0] op_sel_hi:[1,0,1]
v_pk_fma_f32 v[80:81], v[192:193], v[56:57], v[80:81] op_sel:[0,1,0] op_sel_hi:[1,1,1]
v_pk_fma_f32 v[82:83], v[194:195], v[56:57], v[82:83] op_sel:[0,1,0] op_sel_hi:[1,1,1]
buffer_load_dwordx4 v[188:191], v4, s[4:7], s91 offen offset:1536 nt
buffer_load_dwordx4 v[192:195], v4, s[4:7], s91 offen offset:1792 nt
v_mov_b32_dpp v56, v84 row_newbcast:2 row_mask:0xf bank_mask:0xf
v_mov_b32_dpp v57, v85 row_newbcast:2 row_mask:0xf bank_mask:0xf
s_cmp_lg_u32 s88, 7
s_cbranch_scc1 L_notk
s_waitcnt vmcnt(24)
s_mov_b64 exec, 1
buffer_atomic_add v90, off, s[52:55], s96 sc0 sc1
s_mov_b64 exec, -1
L_notk:
s_waitcnt vmcnt(22)
v_cvt_f32_i32 v100, v100
v_cvt_f32_i32 v101, v101
v_cvt_f32_i32 v102, v102
v_cvt_f32_i32 v103, v103
v_cvt_f32_i32 v104, v104
v_cvt_f32_i32 v105, v105
v_cvt_f32_i32 v106, v106
v_cvt_f32_i32 v107, v107
v_pk_fma_f32 v[76:77], v[100:101], v[56:57], v[76:77] op_sel:[0,0,0] op_sel_hi:[1,0,1]
v_pk_fma_f32 v[78:79], v[102:103], v[56:57], v[78:79] op_sel:[0,0,0] op_sel_hi:[1,0,1]
v_pk_fma_f32 v[80:81], v[104:105], v[56:57], v[80:81] op_sel:[0,1,0] op_sel_hi:[1,1,1]
v_pk_fma_f32 v[82:83], v[106:107], v[56:57], v[82:83] op_sel:[0,1,0] op_sel_hi:[1,1,1]
buffer_load_dwordx4 v[100:103], v3, s[8:11], s91 offen offset:0 nt
buffer_load_dwordx4 v[104:107], v3, s[8:11], s91 offen offset:256 nt
v_mov_b32_dpp v56, v84 row_newbcast:10 row_mask:0xf bank_mask:0xf
v_mov_b32_dpp v57, v85 row_newbcast:10 row_mask:0xf bank_mask:0xf
s_waitcnt vmcnt(22)
v_cvt_f32_i32 v108, v108
v_cvt_f32_i32 v109, v109
v_cvt_f32_i32 v110, v110
v_cvt_f32_i32 v111, v111
v_cvt_f32_i32 v112, v112
v_cvt_f32_i32 v113, v113
v_cvt_f32_i32 v114, v114
v_cvt_f32_i32 v115, v115
v_pk_fma_f32 v[76:77], v[108:109], v[56:57], v[76:77] op_sel:[0,0,0] op_sel_hi:[1,0,1]
v_pk_fma_f32 v[78:79], v[110:111], v[56:57], v[78:79] op_sel:[0,0,0] op_sel_hi:[1,0,1]
v_pk_fma_f32 v[80:81], v[112:113], v[56:57], v[80:81] op_sel:[0,1,0] op_sel_hi:[1,1,1]
v_pk_fma_f32 v[82:83], v[114:115], v[56:57], v[82:83] op_sel:[0,1,0] op_sel_hi:[1,1,1]
buffer_load_dwordx4 v[108:111], v3, s[8:11], s91 offen offset:512 nt
buffer_load_dwordx4 v[112:115], v3, s[8:11], s91 offen offset:768 nt
v_mov_b32_dpp v56, v84 row_newbcast:6 row_mask:0xf bank_mask:0xf
v_mov_b32_dpp v57, v85 row_newbcast:6 row_mask:0xf bank_mask:0xf
s_waitcnt vmcnt(22)
v_cvt_f32_i32 v116, v116
v_cvt_f32_i32 v117, v117
v_cvt_f32_i32 v118, v118
v_cvt_f32_i32 v119, v119
v_cvt_f32_i32 v120, v120
v_cvt_f32_i32 v121, v121
v_cvt_f32_i32 v122, v122
v_cvt_f32_i32 v123, v123
v_pk_fma_f32 v[76:77], v[116:117], v[56:57], v[76:77] op_sel:[0,0,0] op_sel_hi:[1,0,1]
v_pk_fma_f32 v[78:79], v[118:119], v[56:57], v[78:79] op_sel:[0,0,0] op_sel_hi:[1,0,1]
v_pk_fma_f32 v[80:81], v[120:121], v[56:57], v[80:81] op_sel:[0,1,0] op_sel_hi:[1,1,1]
v_pk_fma_f32 v[82:83], v[122:123], v[56:57], v[82:83] op_sel:[0,1,0] op_sel_hi:[1,1,1]
buffer_load_dwordx4 v[116:119], v3, s[8:11], s91 offen offset:1024 nt
buffer_load_dwordx4 v[120:123], v3, s[8:11], s91 offen offset:1280 nt
v_mov_b32_dpp v56, v84 row_newbcast:14 row_mask:0xf bank_mask:0xf
v_mov_b32_dpp v57, v85 row_newbcast:14 row_mask:0xf bank_mask:0xf
s_waitcnt vmcnt(22)
v_cvt_f32_i32 v124, v124
v_cvt_f32_i32 v125, v125
v_cvt_f32_i32 v126, v126
v_cvt_f32_i32 v127, v127
v_cvt_f32_i32 v128, v128
v_cvt_f32_i32 v129, v129
v_cvt_f32_i32 v130, v130
v_cvt_f32_i32 v131, v131
v_pk_fma_f32 v[76:77], v[124:125], v[56:57], v[76:77] op_sel:[0,0,0] op_sel_hi:[1,0,1]
v_pk_fma_f32 v[78:79], v[126:127], v[56:57], v[78:79] op_sel:[0,0,0] op_sel_hi:[1,0,1]
v_pk_fma_f32 v[80:81], v[128:129], v[56:57], v[80:81] op_sel:[0,1,0] op_sel_hi:[1,1,1]
v_pk_fma_f32 v[82:83], v[130:131], v[56:57], v[82:83] op_sel:[0,1,0] op_sel_hi:[1,1,1]
buffer_load_dwordx4 v[124:127], v3, s[8:11], s91 offen offset:1536 nt
buffer_load_dwordx4 v[128:131], v3, s[8:11], s91 offen offset:1792 nt
s_waitcnt lgkmcnt(0)
v_dot2_f32_bf16 v40, v28, v20, 0
v_dot2_f32_bf16 v41, v29, v21, 0
v_dot2_f32_bf16 v42, v30, v22, 0
v_dot2_f32_bf16 v43, v31, v23, 0
v_dot2_f32_bf16 v36, v28, v16, 0
v_dot2_f32_bf16 v37, v29, v17, 0
v_dot2_f32_bf16 v38, v30, v18, 0
v_dot2_f32_bf16 v39, v31, v19, 0
ds_read_b128 v[28:31], v7 offset:256
v_mov_b32_dpp v56, v44 row_newbcast:1 row_mask:0xf bank_mask:0xf
v_mov_b32_dpp v57, v45 row_newbcast:1 row_mask:0xf bank_mask:0xf
s_waitcnt vmcnt(22)
v_cvt_f32_i32 v132, v132
v_cvt_f32_i32 v133, v133
v_cvt_f32_i32 v134, v134
v_cvt_f32_i32 v135, v135
v_cvt_f32_i32 v136, v136
v_cvt_f32_i32 v137, v137
v_cvt_f32_i32 v138, v138
v_cvt_f32_i32 v139, v139
v_pk_add_f32 v[132:133], v[132:133], v[56:57] op_sel:[0,0] op_sel_hi:[1,0] neg_lo:[0,1] neg_hi:[0,1]
v_pk_add_f32 v[134:135], v[134:135], v[56:57] op_sel:[0,0] op_sel_hi:[1,0] neg_lo:[0,1] neg_hi:[0,1]
v_pk_add_f32 v[136:137], v[136:137], v[56:57] op_sel:[0,1] op_sel_hi:[1,1] neg_lo:[0,1] neg_hi:[0,1]
v_pk_add_f32 v[138:139], v[138:139], v[56:57] op_sel:[0,1] op_sel_hi:[1,1] neg_lo:[0,1] neg_hi:[0,1]
v_pk_mul_f32 v[58:59], v[132:133], v[36:37]
v_pk_mul_f32 v[60:61], v[136:137], v[40:41]
v_pk_fma_f32 v[58:59], v[134:135], v[38:39], v[58:59]
v_pk_fma_f32 v[60:61], v[138:139], v[42:43], v[60:61]
v_add_f32 v52, v58, v59
v_add_f32 v53, v60, v61
buffer_load_dwordx4 v[132:135], v4, s[8:11], s91 offen offset:0 nt
buffer_load_dwordx4 v[136:139], v4, s[8:11], s91 offen offset:256 nt
v_mul_f32_dpp v63, v46, v52 row_newbcast:1 row_mask:0xf bank_mask:0xf
v_mul_f32_dpp v52, v47, v53 row_newbcast:1 row_mask:0xf bank_mask:0xf
v_add_f32 v63, v63, v52
s_waitcnt lgkmcnt(0)
v_dot2_f32_bf16 v40, v28, v20, 0
v_dot2_f32_bf16 v41, v29, v21, 0
v_dot2_f32_bf16 v42, v30, v22, 0
v_dot2_f32_bf16 v43, v31, v23, 0
v_dot2_f32_bf16 v36, v28, v16, 0
v_dot2_f32_bf16 v37, v29, v17, 0
v_dot2_f32_bf16 v38, v30, v18, 0
v_dot2_f32_bf16 v39, v31, v19, 0
ds_read_b128 v[28:31], v7 offset:512
v_mov_b32_dpp v56, v44 row_newbcast:9 row_mask:0xf bank_mask:0xf
v_mov_b32_dpp v57, v45 row_newbcast:9 row_mask:0xf bank_mask:0xf
s_waitcnt vmcnt(22)
v_cvt_f32_i32 v140, v140
v_cvt_f32_i32 v141, v141
v_cvt_f32_i32 v142, v142
v_cvt_f32_i32 v143, v143
v_cvt_f32_i32 v144, v144
v_cvt_f32_i32 v145, v145
v_cvt_f32_i32 v146, v146
v_cvt_f32_i32 v147, v147
v_pk_add_f32 v[140:141], v[140:141], v[56:57] op_sel:[0,0] op_sel_hi:[1,0] neg_lo:[0,1] neg_hi:[0,1]
v_pk_add_f32 v[142:143], v[142:143], v[56:57] op_sel:[0,0] op_sel_hi:[1,0] neg_lo:[0,1] neg_hi:[0,1]
v_pk_add_f32 v[144:145], v[144:145], v[56:57] op_sel:[0,1] op_sel_hi:[1,1] neg_lo:[0,1] neg_hi:[0,1]
v_pk_add_f32 v[146:147], v[146:147], v[56:57] op_sel:[0,1] op_sel_hi:[1,1] neg_lo:[0,1] neg_hi:[0,1]
v_pk_mul_f32 v[58:59], v[140:141], v[36:37]
v_pk_mul_f32 v[60:61], v[144:145], v[40:41]
v_pk_fma_f32 v[58:59], v[142:143], v[38:39], v[58:59]
v_pk_fma_f32 v[60:61], v[146:147], v[42:43], v[60:61]
v_add_f32 v52, v58, v59
v_add_f32 v53, v60, v61
buffer_load_dwordx4 v[140:143], v4, s[8:11], s91 offen offset:512 nt
buffer_load_dwordx4 v[144:147], v4, s[8:11], s91 offen offset:768 nt
v_mul_f32_dpp v64, v46, v52 row_newbcast:9 row_mask:0xf bank_mask:0xf
v_mul_f32_dpp v52, v47, v53 row_newbcast:9 row_mask:0xf bank_mask:0xf
v_add_f32 v64, v64, v52
s_waitcnt lgkmcnt(0)
v_dot2_f32_bf16 v40, v28, v20, 0
v_dot2_f32_bf16 v41, v29, v21, 0
v_add_f32_dpp v65, v63, v63 row_ror:8 row_mask:0xf bank_mask:0x3
v_dot2_f32_bf16 v42, v30, v22, 0
v_dot2_f32_bf16 v43, v31, v23, 0
v_add_f32_dpp v65, v64, v64 row_ror:8 row_mask:0xf bank_mask:0xc
v_dot2_f32_bf16 v36, v28, v16, 0
v_dot2_f32_bf16 v37, v29, v17, 0
v_dot2_f32_bf16 v38, v30, v18, 0
v_dot2_f32_bf16 v39, v31, v19, 0
ds_read_b128 v[28:31], v7 offset:768
v_mov_b32_dpp v56, v44 row_newbcast:5 row_mask:0xf bank_mask:0xf
v_mov_b32_dpp v57, v45 row_newbcast:5 row_mask:0xf bank_mask:0xf
s_waitcnt vmcnt(22)
v_cvt_f32_i32 v148, v148
v_cvt_f32_i32 v149, v149
v_cvt_f32_i32 v150, v150
v_cvt_f32_i32 v151, v151
v_cvt_f32_i32 v152, v152
v_cvt_f32_i32 v153, v153
v_cvt_f32_i32 v154, v154
v_cvt_f32_i32 v155, v155
v_pk_add_f32 v[148:149], v[148:149], v[56:57] op_sel:[0,0] op_sel_hi:[1,0] neg_lo:[0,1] neg_hi:[0,1]
v_pk_add_f32 v[150:151], v[150:151], v[56:57] op_sel:[0,0] op_sel_hi:[1,0] neg_lo:[0,1] neg_hi:[0,1]
v_pk_add_f32 v[152:153], v[152:153], v[56:57] op_sel:[0,1] op_sel_hi:[1,1] neg_lo:[0,1] neg_hi:[0,1]
v_pk_add_f32 v[154:155], v[154:155], v[56:57] op_sel:[0,1] op_sel_hi:[1,1] neg_lo:[0,1] neg_hi:[0,1]
v_pk_mul_f32 v[58:59], v[148:149], v[36:37]
v_pk_mul_f32 v[60:61], v[152:153], v[40:41]
v_pk_fma_f32 v[58:59], v[150:151], v[38:39], v[58:59]
v_pk_fma_f32 v[60:61], v[154:155], v[42:43], v[60:61]
v_add_f32 v52, v58, v59
v_add_f32 v53, v60, v61
buffer_load_dwordx4 v[148:151], v4, s[8:11], s91 offen offset:1024 nt
buffer_load_dwordx4 v[152:155], v4, s[8:11], s91 offen offset:1280 nt
v_mul_f32_dpp v63, v46, v52 row_newbcast:5 row_mask:0xf bank_mask:0xf
v_mul_f32_dpp v52, v47, v53 row_newbcast:5 row_mask:0xf bank_mask:0xf
v_add_f32 v63, v63, v52
s_waitcnt lgkmcnt(0)
v_dot2_f32_bf16 v40, v28, v20, 0
v_dot2_f32_bf16 v41, v29, v21, 0
v_dot2_f32_bf16 v42, v30, v22, 0
v_dot2_f32_bf16 v43, v31, v23, 0
v_dot2_f32_bf16 v36, v28, v16, 0
v_dot2_f32_bf16 v37, v29, v17, 0
v_dot2_f32_bf16 v38, v30, v18, 0
v_dot2_f32_bf16 v39, v31, v19, 0
ds_read_b128 v[28:31], v8 offset:0
v_mov_b32_dpp v56, v44 row_newbcast:13 row_mask:0xf bank_mask:0xf
v_mov_b32_dpp v57, v45 row_newbcast:13 row_mask:0xf bank_mask:0xf
s_waitcnt vmcnt(22)
v_cvt_f32_i32 v156, v156
v_cvt_f32_i32 v157, v157
v_cvt_f32_i32 v158, v158
v_cvt_f32_i32 v159, v159
v_cvt_f32_i32 v160, v160
v_cvt_f32_i32 v161, v161
v_cvt_f32_i32 v162, v162
v_cvt_f32_i32 v163, v163
v_pk_add_f32 v[156:157], v[156:157], v[56:57] op_sel:[0,0] op_sel_hi:[1,0] neg_lo:[0,1] neg_hi:[0,1]
v_pk_add_f32 v[158:159], v[158:159], v[56:57] op_sel:[0,0] op_sel_hi:[1,0] neg_lo:[0,1] neg_hi:[0,1]
v_pk_add_f32 v[160:161], v[160:161], v[56:57] op_sel:[0,1] op_sel_hi:[1,1] neg_lo:[0,1] neg_hi:[0,1]
v_pk_add_f32 v[162:163], v[162:163], v[56:57] op_sel:[0,1] op_sel_hi:[1,1] neg_lo:[0,1] neg_hi:[0,1]
v_pk_mul_f32 v[58:59], v[156:157], v[36:37]
v_pk_mul_f32 v[60:61], v[160:161], v[40:41]
v_pk_fma_f32 v[58:59], v[158:159], v[38:39], v[58:59]
v_pk_fma_f32 v[60:61], v[162:163], v[42:43], v[60:61]
v_add_f32 v52, v58, v59
v_add_f32 v53, v60, v61
buffer_load_dwordx4 v[156:159], v4, s[8:11], s91 offen offset:1536 nt
buffer_load_dwordx4 v[160:163], v4, s[8:11], s91 offen offset:1792 nt
v_mul_f32_dpp v64, v46, v52 row_newbcast:13 row_mask:0xf bank_mask:0xf
v_mul_f32_dpp v52, v47, v53 row_newbcast:13 row_mask:0xf bank_mask:0xf
v_add_f32 v64, v64, v52
s_waitcnt lgkmcnt(0)
v_dot2_f32_bf16 v40, v28, v20, 0
v_dot2_f32_bf16 v41, v29, v21, 0
v_add_f32_dpp v66, v63, v63 row_ror:8 row_mask:0xf bank_mask:0x3
v_dot2_f32_bf16 v42, v30, v22, 0
v_dot2_f32_bf16 v43, v31, v23, 0
v_add_f32_dpp v66, v64, v64 row_ror:8 row_mask:0xf bank_mask:0xc
v_dot2_f32_bf16 v36, v28, v16, 0
v_dot2_f32_bf16 v37, v29, v17, 0
v_add_f32_dpp v67, v65, v65 row_half_mirror row_mask:0xf bank_mask:0x5
v_dot2_f32_bf16 v38, v30, v18, 0
v_dot2_f32_bf16 v39, v31, v19, 0
v_add_f32_dpp v67, v66, v66 row_half_mirror row_mask:0xf bank_mask:0xa
ds_read_b128 v[28:31], v8 offset:256
v_mov_b32_dpp v56, v44 row_newbcast:3 row_mask:0xf bank_mask:0xf
v_mov_b32_dpp v57, v45 row_newbcast:3 row_mask:0xf bank_mask:0xf
s_waitcnt vmcnt(22)
v_cvt_f32_i32 v164, v164
v_cvt_f32_i32 v165, v165
v_cvt_f32_i32 v166, v166
v_cvt_f32_i32 v167, v167
v_cvt_f32_i32 v168, v168
v_cvt_f32_i32 v169, v169
v_cvt_f32_i32 v170, v170
v_cvt_f32_i32 v171, v171
v_pk_add_f32 v[164:165], v[164:165], v[56:57] op_sel:[0,0] op_sel_hi:[1,0] neg_lo:[0,1] neg_hi:[0,1]
v_pk_add_f32 v[166:167], v[166:167], v[56:57] op_sel:[0,0] op_sel_hi:[1,0] neg_lo:[0,1] neg_hi:[0,1]
v_pk_add_f32 v[168:169], v[168:169], v[56:57] op_sel:[0,1] op_sel_hi:[1,1] neg_lo:[0,1] neg_hi:[0,1]
v_pk_add_f32 v[170:171], v[170:171], v[56:57] op_sel:[0,1] op_sel_hi:[1,1] neg_lo:[0,1] neg_hi:[0,1]
v_pk_mul_f32 v[58:59], v[164:165], v[36:37]
v_pk_mul_f32 v[60:61], v[168:169], v[40:41]
v_pk_fma_f32 v[58:59], v[166:167], v[38:39], v[58:59]
v_pk_fma_f32 v[60:61], v[170:171], v[42:43], v[60:61]
v_add_f32 v52, v58, v59
v_add_f32 v53, v60, v61
s_nop 0
v_mul_f32_dpp v63, v46, v52 row_newbcast:3 row_mask:0xf bank_mask:0xf
v_mul_f32_dpp v52, v47, v53 row_newbcast:3 row_mask:0xf bank_mask:0xf
v_add_f32 v63, v63, v52
s_waitcnt lgkmcnt(0)
v_dot2_f32_bf16 v40, v28, v20, 0
v_dot2_f32_bf16 v41, v29, v21, 0
v_dot2_f32_bf16 v42, v30, v22, 0
v_dot2_f32_bf16 v43, v31, v23, 0
v_dot2_f32_bf16 v36, v28, v16, 0
v_dot2_f32_bf16 v37, v29, v17, 0
v_dot2_f32_bf16 v38, v30, v18, 0
v_dot2_f32_bf16 v39, v31, v19, 0
ds_read_b128 v[28:31], v8 offset:512
v_mov_b32_dpp v56, v44 row_newbcast:11 row_mask:0xf bank_mask:0xf
v_mov_b32_dpp v57, v45 row_newbcast:11 row_mask:0xf bank_mask:0xf
s_waitcnt vmcnt(20)
v_cvt_f32_i32 v172, v172
v_cvt_f32_i32 v173, v173
v_cvt_f32_i32 v174, v174
v_cvt_f32_i32 v175, v175
v_cvt_f32_i32 v176, v176
v_cvt_f32_i32 v177, v177
v_cvt_f32_i32 v178, v178
v_cvt_f32_i32 v179, v179
v_pk_add_f32 v[172:173], v[172:173], v[56:57] op_sel:[0,0] op_sel_hi:[1,0] neg_lo:[0,1] neg_hi:[0,1]
v_pk_add_f32 v[174:175], v[174:175], v[56:57] op_sel:[0,0] op_sel_hi:[1,0] neg_lo:[0,1] neg_hi:[0,1]
v_pk_add_f32 v[176:177], v[176:177], v[56:57] op_sel:[0,1] op_sel_hi:[1,1] neg_lo:[0,1] neg_hi:[0,1]
v_pk_add_f32 v[178:179], v[178:179], v[56:57] op_sel:[0,1] op_sel_hi:[1,1] neg_lo:[0,1] neg_hi:[0,1]
v_pk_mul_f32 v[58:59], v[172:173], v[36:37]
v_pk_mul_f32 v[60:61], v[176:177], v[40:41]
v_pk_fma_f32 v[58:59], v[174:175], v[38:39], v[58:59]
v_pk_fma_f32 v[60:61], v[178:179], v[42:43], v[60:61]
v_add_f32 v52, v58, v59
v_add_f32 v53, v60, v61
s_nop 0
v_mul_f32_dpp v64, v46, v52 row_newbcast:11 row_mask:0xf bank_mask:0xf
v_mul_f32_dpp v52, v47, v53 row_newbcast:11 row_mask:0xf bank_mask:0xf
v_add_f32 v64, v64, v52
s_waitcnt lgkmcnt(0)
v_dot2_f32_bf16 v40, v28, v20, 0
v_dot2_f32_bf16 v41, v29, v21, 0
v_add_f32_dpp v65, v63, v63 row_ror:8 row_mask:0xf bank_mask:0x3
v_dot2_f32_bf16 v42, v30, v22, 0
v_dot2_f32_bf16 v43, v31, v23, 0
v_add_f32_dpp v65, v64, v64 row_ror:8 row_mask:0xf bank_mask:0xc
v_dot2_f32_bf16 v36, v28, v16, 0
v_dot2_f32_bf16 v37, v29, v17, 0
v_dot2_f32_bf16 v38, v30, v18, 0
v_dot2_f32_bf16 v39, v31, v19, 0
ds_read_b128 v[28:31], v8 offset:768
v_mov_b32_dpp v56, v44 row_newbcast:7 row_mask:0xf bank_mask:0xf
v_mov_b32_dpp v57, v45 row_newbcast:7 row_mask:0xf bank_mask:0xf
s_waitcnt vmcnt(18)
v_cvt_f32_i32 v180, v180
v_cvt_f32_i32 v181, v181
v_cvt_f32_i32 v182, v182
v_cvt_f32_i32 v183, v183
v_cvt_f32_i32 v184, v184
v_cvt_f32_i32 v185, v185
v_cvt_f32_i32 v186, v186
v_cvt_f32_i32 v187, v187
v_pk_add_f32 v[180:181], v[180:181], v[56:57] op_sel:[0,0] op_sel_hi:[1,0] neg_lo:[0,1] neg_hi:[0,1]
v_pk_add_f32 v[182:183], v[182:183], v[56:57] op_sel:[0,0] op_sel_hi:[1,0] neg_lo:[0,1] neg_hi:[0,1]
v_pk_add_f32 v[184:185], v[184:185], v[56:57] op_sel:[0,1] op_sel_hi:[1,1] neg_lo:[0,1] neg_hi:[0,1]
v_pk_add_f32 v[186:187], v[186:187], v[56:57] op_sel:[0,1] op_sel_hi:[1,1] neg_lo:[0,1] neg_hi:[0,1]
v_pk_mul_f32 v[58:59], v[180:181], v[36:37]
v_pk_mul_f32 v[60:61], v[184:185], v[40:41]
v_pk_fma_f32 v[58:59], v[182:183], v[38:39], v[58:59]
v_pk_fma_f32 v[60:61], v[186:187], v[42:43], v[60:61]
v_add_f32 v52, v58, v59
v_add_f32 v53, v60, v61
s_nop 0
v_mul_f32_dpp v63, v46, v52 row_newbcast:7 row_mask:0xf bank_mask:0xf
v_mul_f32_dpp v52, v47, v53 row_newbcast:7 row_mask:0xf bank_mask:0xf
v_add_f32 v63, v63, v52
s_waitcnt lgkmcnt(0)
v_dot2_f32_bf16 v40, v28, v20, 0
v_dot2_f32_bf16 v41, v29, v21, 0
v_dot2_f32_bf16 v42, v30, v22, 0
v_dot2_f32_bf16 v43, v31, v23, 0
v_dot2_f32_bf16 v36, v28, v16, 0
v_dot2_f32_bf16 v37, v29, v17, 0
v_dot2_f32_bf16 v38, v30, v18, 0
v_dot2_f32_bf16 v39, v31, v19, 0
v_mov_b32_dpp v56, v44 row_newbcast:15 row_mask:0xf bank_mask:0xf
v_mov_b32_dpp v57, v45 row_newbcast:15 row_mask:0xf bank_mask:0xf
s_waitcnt vmcnt(16)
v_cvt_f32_i32 v188, v188
v_cvt_f32_i32 v189, v189
v_cvt_f32_i32 v190, v190
v_cvt_f32_i32 v191, v191
v_cvt_f32_i32 v192, v192
v_cvt_f32_i32 v193, v193
v_cvt_f32_i32 v194, v194
v_cvt_f32_i32 v195, v195
v_pk_add_f32 v[188:189], v[188:189], v[56:57] op_sel:[0,0] op_sel_hi:[1,0] neg_lo:[0,1] neg_hi:[0,1]
v_pk_add_f32 v[190:191], v[190:191], v[56:57] op_sel:[0,0] op_sel_hi:[1,0] neg_lo:[0,1] neg_hi:[0,1]
v_pk_add_f32 v[192:193], v[192:193], v[56:57] op_sel:[0,1] op_sel_hi:[1,1] neg_lo:[0,1] neg_hi:[0,1]
v_pk_add_f32 v[194:195], v[194:195], v[56:57] op_sel:[0,1] op_sel_hi:[1,1] neg_lo:[0,1] neg_hi:[0,1]
v_pk_mul_f32 v[58:59], v[188:189], v[36:37]
v_pk_mul_f32 v[60:61], v[192:193], v[40:41]
v_pk_fma_f32 v[58:59], v[190:191], v[38:39], v[58:59]
v_pk_fma_f32 v[60:61], v[194:195], v[42:43], v[60:61]
v_add_f32 v52, v58, v59
v_add_f32 v53, v60, v61
s_nop 0
v_mul_f32_dpp v64, v46, v52 row_newbcast:15 row_mask:0xf bank_mask:0xf
v_mul_f32_dpp v52, v47, v53 row_newbcast:15 row_mask:0xf bank_mask:0xf
v_add_f32 v64, v64, v52
v_add_f32_dpp v66, v63, v63 row_ror:8 row_mask:0xf bank_mask:0x3
s_nop 1
v_add_f32_dpp v66, v64, v64 row_ror:8 row_mask:0xf bank_mask:0xc
v_add_f32_dpp v68, v65, v65 row_half_mirror row_mask:0xf bank_mask:0x5
s_nop 1
v_add_f32_dpp v68, v66, v66 row_half_mirror row_mask:0xf bank_mask:0xa
v_add_f32_dpp v70, v67, v67 quad_perm:[2,3,0,1] row_mask:0xf bank_mask:0xf
s_nop 0
v_add_f32_dpp v71, v68, v68 quad_perm:[2,3,0,1] row_mask:0xf bank_mask:0xf
v_cndmask_b32 v69, v70, v71, s[60:61]
s_nop 1
v_add_f32_dpp v55, v69, v69 quad_perm:[1,0,3,2] row_mask:0xf bank_mask:0xf
v_mul_f32 v55, 0x3e0293ee, v55
s_nop 1
v_max_f32_dpp v70, v55, v55 row_ror:8 row_mask:0xf bank_mask:0xf
s_nop 1
v_max_f32_dpp v70, v70, v70 row_ror:4 row_mask:0xf bank_mask:0xf
s_nop 1
v_max_f32_dpp v70, v70, v70 row_ror:2 row_mask:0xf bank_mask:0xf
v_max_f32 v70, v70, v86
v_sub_f32 v62, v86, v70
v_mov_b32 v86, v70
v_exp_f32 v62, v62
v_sub_f32 v71, v55, v86
v_exp_f32 v71, v71
s_mov_b32 s62, 0xaaaaaaaa
s_mov_b32 s63, 0xaaaaaaaa
v_cndmask_b32 v71, 0, v71, s[62:63]
v_mul_f32 v84, v71, v50
v_mul_f32 v85, v71, v51
v_mul_f32 v88, v84, v48
v_mul_f32 v89, v85, v49
v_add_f32_dpp v71, v71, v71 row_ror:8 row_mask:0xf bank_mask:0xf
v_add_f32_dpp v88, v88, v88 row_ror:8 row_mask:0xf bank_mask:0xf
v_add_f32_dpp v89, v89, v89 row_ror:8 row_mask:0xf bank_mask:0xf
v_add_f32_dpp v71, v71, v71 row_ror:4 row_mask:0xf bank_mask:0xf
v_add_f32_dpp v88, v88, v88 row_ror:4 row_mask:0xf bank_mask:0xf
v_add_f32_dpp v89, v89, v89 row_ror:4 row_mask:0xf bank_mask:0xf
v_add_f32_dpp v71, v71, v71 row_ror:2 row_mask:0xf bank_mask:0xf
v_add_f32_dpp v88, v88, v88 row_ror:2 row_mask:0xf bank_mask:0xf
v_add_f32_dpp v89, v89, v89 row_ror:2 row_mask:0xf bank_mask:0xf
v_add_f32_dpp v71, v71, v71 row_ror:1 row_mask:0xf bank_mask:0xf
v_add_f32_dpp v88, v88, v88 row_ror:1 row_mask:0xf bank_mask:0xf
v_add_f32_dpp v89, v89, v89 row_ror:1 row_mask:0xf bank_mask:0xf
v_fma_f32 v87, v87, v62, v71
v_fma_f32 v76, v76, v62, -v88
v_fma_f32 v77, v77, v62, -v88
v_fma_f32 v78, v78, v62, -v88
v_fma_f32 v79, v79, v62, -v88
v_fma_f32 v80, v80, v62, -v89
v_fma_f32 v81, v81, v62, -v89
v_fma_f32 v82, v82, v62, -v89
v_fma_f32 v83, v83, v62, -v89
ds_write_b64 v93, v[86:87]
v_mov_b32_dpp v56, v84 row_newbcast:1 row_mask:0xf bank_mask:0xf
v_mov_b32_dpp v57, v85 row_newbcast:1 row_mask:0xf bank_mask:0xf
s_waitcnt vmcnt(14)
v_cvt_f32_i32 v100, v100
v_cvt_f32_i32 v101, v101
v_cvt_f32_i32 v102, v102
v_cvt_f32_i32 v103, v103
v_cvt_f32_i32 v104, v104
v_cvt_f32_i32 v105, v105
v_cvt_f32_i32 v106, v106
v_cvt_f32_i32 v107, v107
v_pk_fma_f32 v[76:77], v[100:101], v[56:57], v[76:77] op_sel:[0,0,0] op_sel_hi:[1,0,1]
v_pk_fma_f32 v[78:79], v[102:103], v[56:57], v[78:79] op_sel:[0,0,0] op_sel_hi:[1,0,1]
v_pk_fma_f32 v[80:81], v[104:105], v[56:57], v[80:81] op_sel:[0,1,0] op_sel_hi:[1,1,1]
v_pk_fma_f32 v[82:83], v[106:107], v[56:57], v[82:83] op_sel:[0,1,0] op_sel_hi:[1,1,1]
v_mov_b32_dpp v56, v84 row_newbcast:9 row_mask:0xf bank_mask:0xf
v_mov_b32_dpp v57, v85 row_newbcast:9 row_mask:0xf bank_mask:0xf
s_cmp_lg_u32 s88, 7
s_cbranch_scc1 L_noprep
v_readfirstlane_b32 s84, v90
s_nop 3
v_and_b32 v98, 63, v0
v_lshrrev_b32 v96, 3, v98
v_lshlrev_b32 v97, 3, v98
v_and_b32 v98, 7, v98
v_mul_u32_u24 v96, 17408, v96
v_lshl_add_u32 v96, v98, 4, v96
v_lshlrev_b32 v98, 3, v98
s_sub_u32 s85, s84, 48
s_bfe_u32 s72, s85, 0x20002
s_and_b32 s73, s85, 3
s_mul_i32 s74, s89, 139264
s_lshl_b32 s75, s72, 9
s_add_u32 s74, s74, s75
s_lshl_b32 s76, s89, 11
s_add_u32 s76, s76, s75
s_add_u32 s76, s76, 557056
s_lshl_b32 s75, s73, 7
s_add_u32 s74, s74, s75
s_add_u32 s77, s74, 2176
s_add_u32 s78, s74, 4352
s_add_u32 s79, s74, 6528
s_add_u32 s80, s74, 8704
s_add_u32 s81, s74, 10880
s_add_u32 s82, s74, 13056
s_add_u32 s83, s74, 15232
s_lshl_b32 s70, s89, 2
s_add_u32 s70, s70, s72
s_lshl_b32 s70, s70, 8
s_lshl_b32 s71, s73, 6
s_add_u32 s70, s70, s71
L_noprep:
s_waitcnt vmcnt(12)
v_cvt_f32_i32 v108, v108
v_cvt_f32_i32 v109, v109
v_cvt_f32_i32 v110, v110
v_cvt_f32_i32 v111, v111
v_cvt_f32_i32 v112, v112
v_cvt_f32_i32 v113, v113
v_cvt_f32_i32 v114, v114
v_cvt_f32_i32 v115, v115
v_pk_fma_f32 v[76:77], v[108:109], v[56:57], v[76:77] op_sel:[0,0,0] op_sel_hi:[1,0,1]
v_pk_fma_f32 v[78:79], v[110:111], v[56:57], v[78:79] op_sel:[0,0,0] op_sel_hi:[1,0,1]
v_pk_fma_f32 v[80:81], v[112:113], v[56:57], v[80:81] op_sel:[0,1,0] op_sel_hi:[1,1,1]
v_pk_fma_f32 v[82:83], v[114:115], v[56:57], v[82:83] op_sel:[0,1,0] op_sel_hi:[1,1,1]
v_mov_b32_dpp v56, v84 row_newbcast:5 row_mask:0xf bank_mask:0xf
v_mov_b32_dpp v57, v85 row_newbcast:5 row_mask:0xf bank_mask:0xf
s_waitcnt vmcnt(10)
v_cvt_f32_i32 v116, v116
v_cvt_f32_i32 v117, v117
v_cvt_f32_i32 v118, v118
v_cvt_f32_i32 v119, v119
v_cvt_f32_i32 v120, v120
v_cvt_f32_i32 v121, v121
v_cvt_f32_i32 v122, v122
v_cvt_f32_i32 v123, v123
v_pk_fma_f32 v[76:77], v[116:117], v[56:57], v[76:77] op_sel:[0,0,0] op_sel_hi:[1,0,1]
v_pk_fma_f32 v[78:79], v[118:119], v[56:57], v[78:79] op_sel:[0,0,0] op_sel_hi:[1,0,1]
v_pk_fma_f32 v[80:81], v[120:121], v[56:57], v[80:81] op_sel:[0,1,0] op_sel_hi:[1,1,1]
v_pk_fma_f32 v[82:83], v[122:123], v[56:57], v[82:83] op_sel:[0,1,0] op_sel_hi:[1,1,1]
v_mov_b32_dpp v56, v84 row_newbcast:13 row_mask:0xf bank_mask:0xf
v_mov_b32_dpp v57, v85 row_newbcast:13 row_mask:0xf bank_mask:0xf
s_waitcnt vmcnt(8)
v_cvt_f32_i32 v124, v124
v_cvt_f32_i32 v125, v125
v_cvt_f32_i32 v126, v126
v_cvt_f32_i32 v127, v127
v_cvt_f32_i32 v128, v128
v_cvt_f32_i32 v129, v129
v_cvt_f32_i32 v130, v130
v_cvt_f32_i32 v131, v131
v_pk_fma_f32 v[76:77], v[124:125], v[56:57], v[76:77] op_sel:[0,0,0] op_sel_hi:[1,0,1]
v_pk_fma_f32 v[78:79], v[126:127], v[56:57], v[78:79] op_sel:[0,0,0] op_sel_hi:[1,0,1]
v_pk_fma_f32 v[80:81], v[128:129], v[56:57], v[80:81] op_sel:[0,1,0] op_sel_hi:[1,1,1]
v_pk_fma_f32 v[82:83], v[130:131], v[56:57], v[82:83] op_sel:[0,1,0] op_sel_hi:[1,1,1]
v_mov_b32_dpp v56, v84 row_newbcast:3 row_mask:0xf bank_mask:0xf
v_mov_b32_dpp v57, v85 row_newbcast:3 row_mask:0xf bank_mask:0xf
s_waitcnt vmcnt(6)
v_cvt_f32_i32 v132, v132
v_cvt_f32_i32 v133, v133
v_cvt_f32_i32 v134, v134
v_cvt_f32_i32 v135, v135
v_cvt_f32_i32 v136, v136
v_cvt_f32_i32 v137, v137
v_cvt_f32_i32 v138, v138
v_cvt_f32_i32 v139, v139
v_pk_fma_f32 v[76:77], v[132:133], v[56:57], v[76:77] op_sel:[0,0,0] op_sel_hi:[1,0,1]
v_pk_fma_f32 v[78:79], v[134:135], v[56:57], v[78:79] op_sel:[0,0,0] op_sel_hi:[1,0,1]
v_pk_fma_f32 v[80:81], v[136:137], v[56:57], v[80:81] op_sel:[0,1,0] op_sel_hi:[1,1,1]
v_pk_fma_f32 v[82:83], v[138:139], v[56:57], v[82:83] op_sel:[0,1,0] op_sel_hi:[1,1,1]
v_mov_b32_dpp v56, v84 row_newbcast:11 row_mask:0xf bank_mask:0xf
v_mov_b32_dpp v57, v85 row_newbcast:11 row_mask:0xf bank_mask:0xf
s_waitcnt vmcnt(4)
v_cvt_f32_i32 v140, v140
v_cvt_f32_i32 v141, v141
v_cvt_f32_i32 v142, v142
v_cvt_f32_i32 v143, v143
v_cvt_f32_i32 v144, v144
v_cvt_f32_i32 v145, v145
v_cvt_f32_i32 v146, v146
v_cvt_f32_i32 v147, v147
v_pk_fma_f32 v[76:77], v[140:141], v[56:57], v[76:77] op_sel:[0,0,0] op_sel_hi:[1,0,1]
v_pk_fma_f32 v[78:79], v[142:143], v[56:57], v[78:79] op_sel:[0,0,0] op_sel_hi:[1,0,1]
v_pk_fma_f32 v[80:81], v[144:145], v[56:57], v[80:81] op_sel:[0,1,0] op_sel_hi:[1,1,1]
v_pk_fma_f32 v[82:83], v[146:147], v[56:57], v[82:83] op_sel:[0,1,0] op_sel_hi:[1,1,1]
v_mov_b32_dpp v56, v84 row_newbcast:7 row_mask:0xf bank_mask:0xf
v_mov_b32_dpp v57, v85 row_newbcast:7 row_mask:0xf bank_mask:0xf
s_waitcnt vmcnt(2)
v_cvt_f32_i32 v148, v148
v_cvt_f32_i32 v149, v149
v_cvt_f32_i32 v150, v150
v_cvt_f32_i32 v151, v151
v_cvt_f32_i32 v152, v152
v_cvt_f32_i32 v153, v153
v_cvt_f32_i32 v154, v154
v_cvt_f32_i32 v155, v155
v_pk_fma_f32 v[76:77], v[148:149], v[56:57], v[76:77] op_sel:[0,0,0] op_sel_hi:[1,0,1]
v_pk_fma_f32 v[78:79], v[150:151], v[56:57], v[78:79] op_sel:[0,0,0] op_sel_hi:[1,0,1]
v_pk_fma_f32 v[80:81], v[152:153], v[56:57], v[80:81] op_sel:[0,1,0] op_sel_hi:[1,1,1]
v_pk_fma_f32 v[82:83], v[154:155], v[56:57], v[82:83] op_sel:[0,1,0] op_sel_hi:[1,1,1]
v_mov_b32_dpp v56, v84 row_newbcast:15 row_mask:0xf bank_mask:0xf
v_mov_b32_dpp v57, v85 row_newbcast:15 row_mask:0xf bank_mask:0xf
s_waitcnt vmcnt(0)
v_cvt_f32_i32 v156, v156
v_cvt_f32_i32 v157, v157
v_cvt_f32_i32 v158, v158
v_cvt_f32_i32 v159, v159
v_cvt_f32_i32 v160, v160
v_cvt_f32_i32 v161, v161
v_cvt_f32_i32 v162, v162
v_cvt_f32_i32 v163, v163
v_pk_fma_f32 v[76:77], v[156:157], v[56:57], v[76:77] op_sel:[0,0,0] op_sel_hi:[1,0,1]
v_pk_fma_f32 v[78:79], v[158:159], v[56:57], v[78:79] op_sel:[0,0,0] op_sel_hi:[1,0,1]
v_pk_fma_f32 v[80:81], v[160:161], v[56:57], v[80:81] op_sel:[0,1,0] op_sel_hi:[1,1,1]
v_pk_fma_f32 v[82:83], v[162:163], v[56:57], v[82:83] op_sel:[0,1,0] op_sel_hi:[1,1,1]
L_final:
ds_write_b128 v92, v[76:79]
ds_write_b128 v92, v[80:83] offset:256
s_waitcnt lgkmcnt(0)
s_barrier
ds_read_b64 v[116:117], v94
ds_read_b32 v100, v95 offset:0
ds_read_b32 v101, v95 offset:4096
ds_read_b32 v102, v95 offset:8192
ds_read_b32 v103, v95 offset:12288
ds_read_b32 v104, v95 offset:16384
ds_read_b32 v105, v95 offset:20480
ds_read_b32 v106, v95 offset:24576
ds_read_b32 v107, v95 offset:28672
s_waitcnt lgkmcnt(8)
v_max_f32_dpp v86, v116, v116 row_ror:4 row_mask:0xf bank_mask:0xf
s_nop 1
v_max_f32_dpp v86, v86, v86 row_ror:2 row_mask:0xf bank_mask:0xf
s_nop 1
v_max_f32_dpp v86, v86, v86 row_ror:1 row_mask:0xf bank_mask:0xf
v_sub_f32 v116, v116, v86
v_exp_f32 v116, v116
s_waitcnt lgkmcnt(0)
v_mul_f32 v87, v116, v117
v_mul_f32_dpp v52, v116, v100 row_newbcast:0 row_mask:0xf bank_mask:0xf
v_mul_f32_dpp v53, v116, v101 row_newbcast:1 row_mask:0xf bank_mask:0xf
s_nop 0
v_fmac_f32_dpp v52, v116, v102 row_newbcast:2 row_mask:0xf bank_mask:0xf
v_fmac_f32_dpp v53, v116, v103 row_newbcast:3 row_mask:0xf bank_mask:0xf
v_add_f32_dpp v87, v87, v87 row_ror:4 row_mask:0xf bank_mask:0xf
v_fmac_f32_dpp v52, v116, v104 row_newbcast:4 row_mask:0xf bank_mask:0xf
v_fmac_f32_dpp v53, v116, v105 row_newbcast:5 row_mask:0xf bank_mask:0xf
v_add_f32_dpp v87, v87, v87 row_ror:2 row_mask:0xf bank_mask:0xf
v_fmac_f32_dpp v52, v116, v106 row_newbcast:6 row_mask:0xf bank_mask:0xf
v_fmac_f32_dpp v53, v116, v107 row_newbcast:7 row_mask:0xf bank_mask:0xf
v_add_f32_dpp v87, v87, v87 row_ror:1 row_mask:0xf bank_mask:0xf
v_add_f32 v52, v52, v53
v_min_u32 v52, -2, v52
buffer_store_dword v52, v95, s[56:59], s92 offen sc1
s_bitcmp1_b32 s88, 0
s_cbranch_scc1 L_noml
v_min_u32 v86, -2, v86
v_min_u32 v87, -2, v87
s_mov_b64 exec, 1
buffer_store_dwordx2 v[86:87], off, s[56:59], s95 sc1
s_mov_b64 exec, -1
L_noml:
s_cmp_lg_u32 s88, 7
s_cbranch_scc1 L_fin
s_cmp_lt_u32 s84, 48
s_cbranch_scc1 L_fin
s_mov_b32 s85, 0x200000
s_mov_b64 exec, 1
L_spin:
buffer_load_dword v53, off, s[52:55], s96 sc1
s_waitcnt vmcnt(0)
v_readfirstlane_b32 s86, v53
s_sub_u32 s85, s85, 1
s_cbranch_scc1 L_go
s_nop 2
s_cmp_lt_u32 s86, 64
s_cbranch_scc1 L_spin
L_go:
s_mov_b64 exec, -1
s_mov_b32 s85, 0x100000
L_poll:
buffer_load_dwordx2 v[86:87], v97, s[56:59], s76 offen sc1
buffer_load_dwordx4 v[100:103], v96, s[56:59], s74 offen sc1
buffer_load_dwordx4 v[104:107], v96, s[56:59], s77 offen sc1
buffer_load_dwordx4 v[108:111], v96, s[56:59], s78 offen sc1
buffer_load_dwordx4 v[112:115], v96, s[56:59], s79 offen sc1
buffer_load_dwordx4 v[116:119], v96, s[56:59], s80 offen sc1
buffer_load_dwordx4 v[120:123], v96, s[56:59], s81 offen sc1
buffer_load_dwordx4 v[124:127], v96, s[56:59], s82 offen sc1
buffer_load_dwordx4 v[128:131], v96, s[56:59], s83 offen sc1
s_waitcnt vmcnt(8)
v_max_u32 v52, v86, v87
v_cmp_eq_u32 vcc, -1, v52
s_sub_u32 s85, s85, 1
s_cbranch_scc1 L_wts
s_nop 2
s_cbranch_vccz L_wts
s_waitcnt vmcnt(0)
s_branch L_poll
L_wts:
v_max_f32_dpp v70, v86, v86 row_ror:8 row_mask:0xf bank_mask:0xf
s_nop 1
v_max_f32_dpp v70, v70, v70 row_ror:4 row_mask:0xf bank_mask:0xf
s_nop 1
v_max_f32_dpp v70, v70, v70 row_ror:2 row_mask:0xf bank_mask:0xf
s_nop 1
v_max_f32_dpp v70, v70, v70 row_ror:1 row_mask:0xf bank_mask:0xf
v_mov_b32 v71, v70
s_nop 1
v_permlane16_swap_b32 v70, v71
v_max_f32 v70, v70, v71
v_mov_b32 v71, v70
s_nop 1
v_permlane32_swap_b32 v70, v71
v_max_f32 v70, v70, v71
v_sub_f32 v55, v86, v70
v_exp_f32 v55, v55
s_nop 0
v_mul_f32 v54, v55, v87
v_mov_b32_dpp v132, v55 row_newbcast:0 row_mask:0xf bank_mask:0x3
v_mov_b32_dpp v133, v55 row_newbcast:1 row_mask:0xf bank_mask:0x3
v_add_f32_dpp v54, v54, v54 row_ror:8 row_mask:0xf bank_mask:0xf
v_mov_b32_dpp v134, v55 row_newbcast:2 row_mask:0xf bank_mask:0x3
v_mov_b32_dpp v135, v55 row_newbcast:3 row_mask:0xf bank_mask:0x3
v_add_f32_dpp v54, v54, v54 row_ror:4 row_mask:0xf bank_mask:0xf
v_mov_b32_dpp v136, v55 row_newbcast:4 row_mask:0xf bank_mask:0x3
v_mov_b32_dpp v137, v55 row_newbcast:5 row_mask:0xf bank_mask:0x3
v_add_f32_dpp v54, v54, v54 row_ror:2 row_mask:0xf bank_mask:0xf
v_mov_b32_dpp v138, v55 row_newbcast:6 row_mask:0xf bank_mask:0x3
v_mov_b32_dpp v139, v55 row_newbcast:7 row_mask:0xf bank_mask:0x3
v_add_f32_dpp v54, v54, v54 row_ror:1 row_mask:0xf bank_mask:0xf
v_mov_b32_dpp v132, v55 row_newbcast:8 row_mask:0xf bank_mask:0xc
v_mov_b32_dpp v133, v55 row_newbcast:9 row_mask:0xf bank_mask:0xc
v_mov_b32_dpp v134, v55 row_newbcast:10 row_mask:0xf bank_mask:0xc
v_mov_b32_dpp v135, v55 row_newbcast:11 row_mask:0xf bank_mask:0xc
v_mov_b32_dpp v136, v55 row_newbcast:12 row_mask:0xf bank_mask:0xc
v_mov_b32_dpp v137, v55 row_newbcast:13 row_mask:0xf bank_mask:0xc
v_mov_b32_dpp v138, v55 row_newbcast:14 row_mask:0xf bank_mask:0xc
v_mov_b32_dpp v139, v55 row_newbcast:15 row_mask:0xf bank_mask:0xc
s_waitcnt vmcnt(6)
v_max3_u32 v52, v100, v101, v102
v_max3_u32 v53, v103, v104, v105
v_max3_u32 v52, v52, v106, v107
s_waitcnt vmcnt(5)
v_max3_u32 v52, v52, v108, v109
v_max3_u32 v53, v53, v110, v111
s_waitcnt vmcnt(4)
v_max3_u32 v52, v52, v112, v113
v_max3_u32 v53, v53, v114, v115
s_waitcnt vmcnt(3)
v_max3_u32 v52, v52, v116, v117
v_max3_u32 v53, v53, v118, v119
s_waitcnt vmcnt(2)
v_max3_u32 v52, v52, v120, v121
v_max3_u32 v53, v53, v122, v123
s_waitcnt vmcnt(1)
v_max3_u32 v52, v52, v124, v125
v_max3_u32 v53, v53, v126, v127
s_waitcnt vmcnt(0)
v_max3_u32 v52, v52, v128, v129
v_max3_u32 v53, v53, v130, v131
v_max_u32 v52, v52, v53
v_cmp_eq_u32 vcc, -1, v52
s_nop 4
s_cbranch_vccz L_have
L_poll2:
buffer_load_dwordx4 v[100:103], v96, s[56:59], s74 offen sc1
buffer_load_dwordx4 v[104:107], v96, s[56:59], s77 offen sc1
buffer_load_dwordx4 v[108:111], v96, s[56:59], s78 offen sc1
buffer_load_dwordx4 v[112:115], v96, s[56:59], s79 offen sc1
buffer_load_dwordx4 v[116:119], v96, s[56:59], s80 offen sc1
buffer_load_dwordx4 v[120:123], v96, s[56:59], s81 offen sc1
buffer_load_dwordx4 v[124:127], v96, s[56:59], s82 offen sc1
buffer_load_dwordx4 v[128:131], v96, s[56:59], s83 offen sc1
s_waitcnt vmcnt(6)
v_max3_u32 v52, v100, v101, v102
v_max3_u32 v53, v103, v104, v105
v_max3_u32 v52, v52, v106, v107
s_waitcnt vmcnt(5)
v_max3_u32 v52, v52, v108, v109
v_max3_u32 v53, v53, v110, v111
s_waitcnt vmcnt(4)
v_max3_u32 v52, v52, v112, v113
v_max3_u32 v53, v53, v114, v115
s_waitcnt vmcnt(3)
v_max3_u32 v52, v52, v116, v117
v_max3_u32 v53, v53, v118, v119
s_waitcnt vmcnt(2)
v_max3_u32 v52, v52, v120, v121
v_max3_u32 v53, v53, v122, v123
s_waitcnt vmcnt(1)
v_max3_u32 v52, v52, v124, v125
v_max3_u32 v53, v53, v126, v127
s_waitcnt vmcnt(0)
v_max3_u32 v52, v52, v128, v129
v_max3_u32 v53, v53, v130, v131
v_max_u32 v52, v52, v53
v_cmp_eq_u32 vcc, -1, v52
s_sub_u32 s85, s85, 1
s_cbranch_scc1 L_have
s_nop 2
s_cbranch_vccnz L_poll2
L_have:
v_mul_f32 v76, v132, v100
v_mul_f32 v77, v132, v101
v_mul_f32 v78, v132, v102
v_mul_f32 v79, v132, v103
v_mov_b32 v71, v54
v_fmac_f32 v76, v133, v104
v_fmac_f32 v77, v133, v105
v_fmac_f32 v78, v133, v106
v_fmac_f32 v79, v133, v107
v_permlane16_swap_b32 v54, v71
v_fmac_f32 v76, v134, v108
v_fmac_f32 v77, v134, v109
v_fmac_f32 v78, v134, v110
v_fmac_f32 v79, v134, v111
v_add_f32 v54, v54, v71
v_mov_b32 v71, v54
v_fmac_f32 v76, v135, v112
v_fmac_f32 v77, v135, v113
v_fmac_f32 v78, v135, v114
v_fmac_f32 v79, v135, v115
v_permlane32_swap_b32 v54, v71
v_fmac_f32 v76, v136, v116
v_fmac_f32 v77, v136, v117
v_fmac_f32 v78, v136, v118
v_fmac_f32 v79, v136, v119
v_add_f32 v54, v54, v71
v_fmac_f32 v76, v137, v120
v_fmac_f32 v77, v137, v121
v_fmac_f32 v78, v137, v122
v_fmac_f32 v79, v137, v123
v_rcp_f32 v54, v54
v_fmac_f32 v76, v138, v124
v_fmac_f32 v77, v138, v125
v_fmac_f32 v78, v138, v126
v_fmac_f32 v79, v138, v127
v_fmac_f32 v76, v139, v128
v_fmac_f32 v77, v139, v129
v_fmac_f32 v78, v139, v130
v_fmac_f32 v79, v139, v131
v_add_f32_dpp v76, v76, v76 row_ror:8 row_mask:0xf bank_mask:0xf
v_add_f32_dpp v77, v77, v77 row_ror:8 row_mask:0xf bank_mask:0xf
v_add_f32_dpp v78, v78, v78 row_ror:8 row_mask:0xf bank_mask:0xf
v_add_f32_dpp v79, v79, v79 row_ror:8 row_mask:0xf bank_mask:0xf
v_mov_b32 v80, v76
v_mov_b32 v81, v77
v_mov_b32 v82, v78
v_mov_b32 v83, v79
v_permlane16_swap_b32 v76, v80
v_permlane16_swap_b32 v77, v81
v_permlane16_swap_b32 v78, v82
v_permlane16_swap_b32 v79, v83
v_add_f32 v76, v76, v80
v_add_f32 v77, v77, v81
v_add_f32 v78, v78, v82
v_add_f32 v79, v79, v83
v_mov_b32 v80, v76
v_mov_b32 v81, v77
v_mov_b32 v82, v78
v_mov_b32 v83, v79
v_permlane32_swap_b32 v76, v80
v_permlane32_swap_b32 v77, v81
v_permlane32_swap_b32 v78, v82
v_permlane32_swap_b32 v79, v83
v_add_f32 v76, v76, v80
v_add_f32 v77, v77, v81
v_add_f32 v78, v78, v82
v_add_f32 v79, v79, v83
v_mul_f32 v76, v76, v54
v_mul_f32 v77, v77, v54
v_mul_f32 v78, v78, v54
v_mul_f32 v79, v79, v54
v_cvt_pk_bf16_f32 v76, v76, v77
v_cvt_pk_bf16_f32 v77, v78, v79
s_mov_b64 exec, 0xff
buffer_store_dwordx2 v[76:77], v98, s[48:51], s70 offen
L_fin:
L_end:
s_endpgm
.section .rodata,"a"
.p2align 6
.amdhsa_kernel standalone__kv_cache_quant_pre_rope_vs_post_rope__decode_kernel
  .amdhsa_next_free_vgpr 200
  .amdhsa_next_free_sgpr 102
  .amdhsa_accum_offset 200
  .amdhsa_group_segment_fixed_size 0
  .amdhsa_kernarg_size 112
  .amdhsa_user_sgpr_count 2
  .amdhsa_user_sgpr_kernarg_segment_ptr 1
  .amdhsa_system_sgpr_workgroup_id_x 1
.end_amdhsa_kernel
```
